```python
import torch

def _softmax(x, axis=-1):
    return torch.softmax(x, dim=axis)
def _gelu(x):
    return torch.nn.functional.gelu(x, approximate="tanh")
def _silu(x):
    return torch.nn.functional.silu(x)
def _sigmoid(x):
    return torch.sigmoid(x)
def _layernorm(x, axis=-1, eps=1e-5):
    m = x.mean(dim=axis, keepdim=True)
    v = x.var(dim=axis, keepdim=True, unbiased=False)
    return (x - m) / torch.sqrt(v + eps)
def _scatter_add(tgt, idx, src, axis=0):
    return tgt.clone().index_add_(axis, idx, src)
def _segment_sum(src, seg, n):
    out = torch.zeros((n,) + src.shape[1:], dtype=src.dtype)
    return out.index_add_(0, seg, src)
def _pad(x, pw):
    flat = tuple(v for pair in reversed(pw) for v in pair)
    return torch.nn.functional.pad(x, flat)

kernel_name = 'recurrent_scan__sliding_block_cached__dense_activation_relu__decode'

def setup_inputs():

    _w = (lambda a: (lambda t: t.to(torch.bfloat16) if t.is_floating_point() else t)(torch.as_tensor(a)))
    def _A_setup():
        B, Sq, D = 2, 1, 1024
        Hq, Hkv, Sk, Dh = 32, 4, 32768, 128
        assert Hq % Hkv == 0, (Hq, Hkv)
        return {
            "x": _w((lambda *s: torch.randn(*s, dtype=torch.bfloat16) * 0.05)(B, Sq, D)),
            "k_cache": _w((lambda *s: torch.randn(*s, dtype=torch.bfloat16) * 1.6)(B, Hkv, Sk, Dh)),
            "v_cache": _w((lambda *s: torch.randn(*s, dtype=torch.bfloat16) * 0.2)(B, Hkv, Sk, Dh)),
            "wq": _w((lambda *s: torch.randn(*s, dtype=torch.bfloat16) * 1.6)(D, Hq * Dh) * (D ** -0.5)),
            "wo": _w((lambda *s: torch.randn(*s, dtype=torch.bfloat16) * 0.2)(Hq * Dh, D) * ((Hq * Dh) ** -0.5)),
        }
    _A_in = _A_setup()

    def _B_setup():
        B, S, D, Dff = 2, 1, 1024, 3584
        return {
            "x": _w((lambda *s: torch.randn(*s, dtype=torch.bfloat16) * 0.05)(B, S, D)),
            "w1": _w((lambda *s: torch.randn(*s, dtype=torch.bfloat16) * 0.1)(D, Dff)),
            "w2": _w((lambda *s: torch.randn(*s, dtype=torch.bfloat16) * 0.1)(Dff, D)),
        }
    _B_in = _B_setup()

    return {
        "A_x": _A_in["x"],
        "A_k_cache": _A_in["k_cache"],
        "A_v_cache": _A_in["v_cache"],
        "A_wq": _A_in["wq"],
        "A_wo": _A_in["wo"],
        "B_x": _B_in["x"],
        "B_w1": _B_in["w1"],
        "B_w2": _B_in["w2"],
    }

def reference(A_x, A_k_cache, A_v_cache, A_wq, A_wo, B_x, B_w1, B_w2):
    def _A_ref(x, k_cache, v_cache, wq, wo):
        B, Sq, D = x.shape
        Hq, Dh = 32, 128
        Hkv, Sk = k_cache.shape[1], k_cache.shape[2]
        W = min(4096, max(256, Sk // 4))
        rep = Hq // Hkv
        q = (lambda x, *d: x.permute(*d))((x @ wq).reshape(B, Sq, Hq, Dh), 0, 2, 1, 3)
        k = (lambda x, n, axis: torch.repeat_interleave(x, n, dim=axis))(k_cache[:, :, Sk - W:, :], rep, axis=1)
        v = (lambda x, n, axis: torch.repeat_interleave(x, n, dim=axis))(v_cache[:, :, Sk - W:, :], rep, axis=1)
        scores = torch.einsum("bhqd,bhkd->bhqk", q, k) * (Dh ** -0.5)
        p = _softmax(scores, axis=-1)
        o = torch.einsum("bhqk,bhkd->bhqd", p, v)
        return (lambda x, *d: x.permute(*d))(o, 0, 2, 1, 3).reshape(B, Sq, Hq * Dh) @ wo

    def _B_ref(x, w1, w2):
        h = torch.einsum("bsd,df->bsf", x, w1)
        zero = torch.zeros_like(h)
        h = torch.maximum(h, zero)
        return torch.einsum("bsf,fd->bsd", h, w2)

    x = A_x
    xn = _layernorm(x, axis=-1)
    s = _A_ref(xn, A_k_cache, A_v_cache, A_wq, A_wo)
    g = _silu(_B_ref(xn, B_w1, B_w2))
    return x + s * g
```

```asm
; @launch grid=(256,1,1) block=(704,1,1) lds=139008
.amdgcn_target "amdgcn-amd-amdhsa--gfx950"
.text
.globl recurrent_scan__sliding_block_cached__dense_activation_relu__decode_kernel
.p2align 8
.type recurrent_scan__sliding_block_cached__dense_activation_relu__decode_kernel,@function
recurrent_scan__sliding_block_cached__dense_activation_relu__decode_kernel:
L_start:
    s_cmp_ge_u32 s2, 256
    s_cbranch_scc1 L_end
    s_load_dwordx16 s[4:19], s[0:1], 0
    s_load_dwordx4 s[20:23], s[0:1], 64
    s_load_dwordx2 s[24:25], s[0:1], 80
    v_lshrrev_b32 v2, 6, v0
    v_and_b32 v1, 63, v0
    v_readfirstlane_b32 s28, v2
    s_and_b32 s26, s2, 7
    s_lshr_b32 s27, s2, 3
    s_and_b32 s36, s27, 3
    s_lshr_b32 s37, s27, 2
    s_and_b32 s56, s37, 1
    s_lshr_b32 s57, s37, 1
    s_lshl_b32 s57, s57, 2
    s_add_u32 s57, s57, s36
    s_add_u32 s58, s26, 3
    s_and_b32 s58, s58, 7
    s_cmp_eq_u32 s28, 0
    s_cbranch_scc1 L_LD
    s_cmp_gt_u32 s28, 2
    s_cbranch_scc1 L_disp
    s_sub_u32 s33, s28, 1
    s_lshl_b32 s30, s33, 11
    v_lshlrev_b32 v3, 5, v1
    v_add_u32 v3, s30, v3
    s_lshl_b32 s31, s36, 9
    s_add_u32 s30, s30, s31
    v_lshlrev_b32 v4, 3, v1
    v_add_u32 v4, s30, v4
    s_waitcnt lgkmcnt(0)
    global_load_dwordx4 v[8:11], v3, s[4:5]
    global_load_dwordx4 v[12:15], v3, s[4:5] offset:16
    global_load_dwordx2 v[16:17], v4, s[4:5]
L_disp:
    s_cmp_lt_u32 s28, 5
    s_cbranch_scc1 L_B
    s_cmp_ge_u32 s28, 9
    s_cbranch_scc1 L_C
    s_branch L_A
L_LD:
    v_lshrrev_b32 v4, 4, v1
    s_mov_b32 s67, 0x20000
    v_bfe_u32 v3, v1, 1, 2
    v_xor_b32 v3, v3, v4
    v_lshlrev_b32 v3, 1, v3
    v_and_b32 v5, 1, v1
    v_or_b32 v3, v3, v5
    v_lshlrev_b32 v3, 4, v3
    v_lshrrev_b32 v5, 3, v1
    v_lshl_add_u32 v10, v5, 13, v3
    s_lshl_b32 s45, s36, 21
    s_lshl_b32 s38, s26, 3
    s_add_u32 s38, s38, s37
    s_lshl_b32 s38, s38, 7
    s_add_u32 s45, s45, s38
    s_mov_b32 s66, 0x800000
    s_mov_b32 s46, 0
    s_mov_b32 s48, 0
    s_mov_b32 s74, 0
    s_waitcnt lgkmcnt(0)
    s_mov_b32 s64, s10
    s_and_b32 s65, s11, 0xffff
L_ld0:
    s_mov_b32 m0, s46
    s_add_u32 s46, s46, 1024
    buffer_load_dwordx4 v10, s[64:67], s45 offen nt lds
    s_add_u32 s45, s45, 65536
    s_mov_b32 m0, s46
    s_add_u32 s46, s46, 1024
    buffer_load_dwordx4 v10, s[64:67], s45 offen nt lds
    s_add_u32 s45, s45, 65536
    s_mov_b32 m0, s46
    s_add_u32 s46, s46, 1024
    buffer_load_dwordx4 v10, s[64:67], s45 offen nt lds
    s_add_u32 s45, s45, 65536
    s_mov_b32 m0, s46
    s_add_u32 s46, s46, 1024
    buffer_load_dwordx4 v10, s[64:67], s45 offen nt lds
    s_add_u32 s45, s45, 65536
    s_add_u32 s48, s48, 4
    s_cmp_lt_u32 s48, 28
    s_cbranch_scc1 L_ld0
    v_and_b32 v6, 15, v1
    v_add_u32 v7, 0, v4
    v_xor_b32 v7, v7, v6
    v_lshlrev_b32 v7, 4, v7
    v_lshl_add_u32 v12, v4, 8, v7
    v_add_u32 v7, 4, v4
    v_xor_b32 v7, v7, v6
    v_lshlrev_b32 v7, 4, v7
    v_lshl_add_u32 v13, v4, 8, v7
    v_add_u32 v7, 8, v4
    v_xor_b32 v7, v7, v6
    v_lshlrev_b32 v7, 4, v7
    v_lshl_add_u32 v14, v4, 8, v7
    v_add_u32 v7, 12, v4
    v_xor_b32 v7, v7, v6
    v_lshlrev_b32 v7, 4, v7
    v_lshl_add_u32 v15, v4, 8, v7
    s_lshl_b32 s42, s26, 23
    s_lshl_b32 s38, s27, 15
    s_add_u32 s42, s42, s38
    s_add_u32 s42, s42, 0x700000
    v_lshlrev_b32 v20, 2, v1
    v_add_u32 v20, 138432, v20
    v_mul_u32_u24 v7, 7168, v5
    v_add_u32 v11, v7, v3
    v_add_u32 v7, 0, v4
    v_lshlrev_b32 v7, 1, v7
    v_xor_b32 v7, v7, v6
    v_lshlrev_b32 v7, 4, v7
    v_lshl_add_u32 v16, v4, 8, v7
    v_lshl_add_u32 v18, v4, 11, v7
    v_add_u32 v7, 4, v4
    v_lshlrev_b32 v7, 1, v7
    v_xor_b32 v7, v7, v6
    v_lshlrev_b32 v7, 4, v7
    v_lshl_add_u32 v17, v4, 8, v7
    v_lshl_add_u32 v19, v4, 11, v7
    s_mov_b32 s50, 0
    s_mov_b32 s75, -1
    s_barrier
L_ld_1:
    s_sub_u32 s49, s48, 24
    s_max_i32 s49, s49, s74
    s_mov_b32 s74, s49
    s_cmp_ge_u32 s49, s75
    s_cselect_b32 s47, s50, 0
    s_add_u32 s49, s49, s47
    v_mov_b32 v21, s49
    s_waitcnt vmcnt(24)
    ds_write_b32 v20, v21
    s_mov_b32 m0, s46
    s_add_u32 s46, s46, 1024
    buffer_load_dwordx4 v10, s[64:67], s45 offen nt lds
    s_add_u32 s45, s45, 65536
    s_mov_b32 m0, s46
    s_add_u32 s46, s46, 1024
    buffer_load_dwordx4 v10, s[64:67], s45 offen nt lds
    s_add_u32 s45, s45, 65536
    s_mov_b32 m0, s46
    s_add_u32 s46, s46, 1024
    buffer_load_dwordx4 v10, s[64:67], s45 offen nt lds
    s_add_u32 s45, s45, 65536
    s_mov_b32 m0, s46
    s_add_u32 s46, s46, 1024
    buffer_load_dwordx4 v10, s[64:67], s45 offen nt lds
    s_add_u32 s45, s45, 65536
    s_add_u32 s48, s48, 4
    s_cmp_lt_u32 s46, 32768
    s_cbranch_scc1 L_ld_1
    s_cmp_eq_u32 s56, 1
    s_cbranch_scc1 L_ldY
    s_mov_b32 s64, s6
    s_and_b32 s65, s7, 0xffff
    s_mov_b32 s66, 67108864
    s_mov_b32 s45, s42
    s_mov_b32 s46, 32768
L_ld_2:
    s_sub_u32 s49, s48, 24
    s_max_i32 s49, s49, s74
    s_mov_b32 s74, s49
    s_cmp_ge_u32 s49, s75
    s_cselect_b32 s47, s50, 0
    s_add_u32 s49, s49, s47
    v_mov_b32 v21, s49
    s_waitcnt vmcnt(24)
    ds_write_b32 v20, v21
    s_mov_b32 m0, s46
    s_add_u32 s46, s46, 1024
    buffer_load_dwordx4 v12, s[64:67], s45 offen nt lds
    s_add_u32 s45, s45, 1024
    s_mov_b32 m0, s46
    s_add_u32 s46, s46, 1024
    buffer_load_dwordx4 v13, s[64:67], s45 offen nt lds
    s_add_u32 s45, s45, 1024
    s_mov_b32 m0, s46
    s_add_u32 s46, s46, 1024
    buffer_load_dwordx4 v14, s[64:67], s45 offen nt lds
    s_add_u32 s45, s45, 1024
    s_mov_b32 m0, s46
    s_add_u32 s46, s46, 1024
    buffer_load_dwordx4 v15, s[64:67], s45 offen nt lds
    s_add_u32 s45, s45, 1024
    s_add_u32 s48, s48, 4
    s_cmp_lt_u32 s46, 65536
    s_cbranch_scc1 L_ld_2
    s_lshl_b32 s43, s57, 19
    s_lshl_b32 s38, s58, 8
    s_add_u32 s43, s43, s38
    s_and_b32 s31, s58, 3
    s_cmp_eq_u32 s31, 1
    s_cbranch_scc1 L_xso
    s_mov_b32 s64, s12
    s_and_b32 s65, s13, 0xffff
    s_mov_b32 s66, 8388608
    s_mov_b32 s45, s43
    s_mov_b32 s46, 65536
L_ld_3:
    s_sub_u32 s49, s48, 24
    s_max_i32 s49, s49, s74
    s_mov_b32 s74, s49
    s_cmp_ge_u32 s49, s75
    s_cselect_b32 s47, s50, 0
    s_add_u32 s49, s49, s47
    v_mov_b32 v21, s49
    s_waitcnt vmcnt(24)
    ds_write_b32 v20, v21
    s_mov_b32 m0, s46
    s_add_u32 s46, s46, 1024
    buffer_load_dwordx4 v18, s[64:67], s45 offen nt lds
    s_add_u32 s45, s45, 8192
    s_mov_b32 m0, s46
    s_add_u32 s46, s46, 1024
    buffer_load_dwordx4 v19, s[64:67], s45 offen nt lds
    s_add_u32 s45, s45, 8192
    s_mov_b32 m0, s46
    s_add_u32 s46, s46, 1024
    buffer_load_dwordx4 v18, s[64:67], s45 offen nt lds
    s_add_u32 s45, s45, 8192
    s_mov_b32 m0, s46
    s_add_u32 s46, s46, 1024
    buffer_load_dwordx4 v19, s[64:67], s45 offen nt lds
    s_add_u32 s45, s45, 8192
    s_add_u32 s48, s48, 4
    s_cmp_lt_u32 s46, 131072
    s_cbranch_scc1 L_ld_3
    s_branch L_ldV
L_xso:
    s_mov_b32 s64, s12
    s_and_b32 s65, s13, 0xffff
    s_mov_b32 s66, 8388608
    s_mov_b32 s45, s43
    s_mov_b32 s46, 65536
L_ld_4:
    s_sub_u32 s49, s48, 32
    s_max_i32 s49, s49, s74
    s_mov_b32 s74, s49
    s_cmp_ge_u32 s49, s75
    s_cselect_b32 s47, s50, 0
    s_add_u32 s49, s49, s47
    v_mov_b32 v21, s49
    s_waitcnt vmcnt(32)
    ds_write_b32 v20, v21
    s_mov_b32 m0, s46
    s_add_u32 s46, s46, 1024
    buffer_load_dwordx4 v18, s[64:67], s45 offen nt lds
    s_add_u32 s45, s45, 8192
    s_mov_b32 m0, s46
    s_add_u32 s46, s46, 1024
    buffer_load_dwordx4 v19, s[64:67], s45 offen nt lds
    s_add_u32 s45, s45, 8192
    s_mov_b32 m0, s46
    s_add_u32 s46, s46, 1024
    buffer_load_dwordx4 v18, s[64:67], s45 offen nt lds
    s_add_u32 s45, s45, 8192
    s_mov_b32 m0, s46
    s_add_u32 s46, s46, 1024
    buffer_load_dwordx4 v19, s[64:67], s45 offen nt lds
    s_add_u32 s45, s45, 8192
    s_add_u32 s48, s48, 4
    s_cmp_lt_u32 s46, 131072
    s_cbranch_scc1 L_ld_4
    s_branch L_ldV
L_ldY:
    s_mul_i32 s41, s36, 1835008
    s_sub_u32 s38, s37, 1
    s_cmp_gt_u32 s37, 3
    s_subb_u32 s38, s38, 0
    s_add_u32 s31, s26, 3
    s_and_b32 s31, s31, 7
    s_cmp_eq_u32 s31, 7
    s_cselect_b32 s31, 2, s31
    s_cmp_eq_u32 s38, s31
    s_cselect_b32 s30, 2, s38
    s_cmp_eq_u32 s38, 2
    s_cselect_b32 s38, s31, s30
    s_mul_i32 s31, s26, 7
    s_add_u32 s38, s38, s31
    s_lshl_b32 s38, s38, 7
    s_add_u32 s43, s41, s38
    s_mov_b32 s64, s6
    s_and_b32 s65, s7, 0xffff
    s_mov_b32 s66, 67108864
    s_mov_b32 s45, s42
    s_mov_b32 s46, 32768
L_ld_5:
    s_sub_u32 s49, s48, 32
    s_max_i32 s49, s49, s74
    s_mov_b32 s74, s49
    s_cmp_ge_u32 s49, s75
    s_cselect_b32 s47, s50, 0
    s_add_u32 s49, s49, s47
    v_mov_b32 v21, s49
    s_waitcnt vmcnt(32)
    ds_write_b32 v20, v21
    s_mov_b32 m0, s46
    s_add_u32 s46, s46, 1024
    buffer_load_dwordx4 v12, s[64:67], s45 offen nt lds
    s_add_u32 s45, s45, 1024
    s_mov_b32 m0, s46
    s_add_u32 s46, s46, 1024
    buffer_load_dwordx4 v13, s[64:67], s45 offen nt lds
    s_add_u32 s45, s45, 1024
    s_mov_b32 m0, s46
    s_add_u32 s46, s46, 1024
    buffer_load_dwordx4 v14, s[64:67], s45 offen nt lds
    s_add_u32 s45, s45, 1024
    s_mov_b32 m0, s46
    s_add_u32 s46, s46, 1024
    buffer_load_dwordx4 v15, s[64:67], s45 offen nt lds
    s_add_u32 s45, s45, 1024
    s_add_u32 s48, s48, 4
    s_cmp_lt_u32 s46, 65536
    s_cbranch_scc1 L_ld_5
    s_mov_b32 s64, s16
    s_and_b32 s65, s17, 0xffff
    s_mov_b32 s66, 7340032
    s_mov_b32 s45, s43
    s_mov_b32 s46, 65536
L_ld_6:
    s_sub_u32 s49, s48, 32
    s_max_i32 s49, s49, s74
    s_mov_b32 s74, s49
    s_cmp_ge_u32 s49, s75
    s_cselect_b32 s47, s50, 0
    s_add_u32 s49, s49, s47
    v_mov_b32 v21, s49
    s_waitcnt vmcnt(32)
    ds_write_b32 v20, v21
    s_mov_b32 m0, s46
    s_add_u32 s46, s46, 1024
    buffer_load_dwordx4 v11, s[64:67], s45 offen nt lds
    s_add_u32 s45, s45, 57344
    s_mov_b32 m0, s46
    s_add_u32 s46, s46, 1024
    buffer_load_dwordx4 v11, s[64:67], s45 offen nt lds
    s_add_u32 s45, s45, 57344
    s_mov_b32 m0, s46
    s_add_u32 s46, s46, 1024
    buffer_load_dwordx4 v11, s[64:67], s45 offen nt lds
    s_add_u32 s45, s45, 57344
    s_mov_b32 m0, s46
    s_add_u32 s46, s46, 1024
    buffer_load_dwordx4 v11, s[64:67], s45 offen nt lds
    s_add_u32 s45, s45, 57344
    s_add_u32 s48, s48, 4
    s_cmp_lt_u32 s46, 98304
    s_cbranch_scc1 L_ld_6
    s_cmp_eq_u32 s37, 3
    s_cselect_b32 s50, 32, 0
    s_cselect_b32 s75, 96, s75
    s_cbranch_scc1 L_ldV
    s_sub_u32 s38, s37, 1
    s_cmp_gt_u32 s37, 3
    s_subb_u32 s38, s38, 0
    s_add_u32 s38, s38, 1
    s_add_u32 s31, s26, 3
    s_and_b32 s31, s31, 7
    s_cmp_eq_u32 s31, 7
    s_cselect_b32 s31, 2, s31
    s_cmp_eq_u32 s38, s31
    s_cselect_b32 s30, 2, s38
    s_cmp_eq_u32 s38, 2
    s_cselect_b32 s38, s31, s30
    s_mul_i32 s31, s26, 7
    s_add_u32 s38, s38, s31
    s_lshl_b32 s38, s38, 7
    s_add_u32 s43, s41, s38
    s_mov_b32 s64, s16
    s_and_b32 s65, s17, 0xffff
    s_mov_b32 s66, 7340032
    s_mov_b32 s45, s43
    s_mov_b32 s46, 98304
L_ld_7:
    s_sub_u32 s49, s48, 32
    s_max_i32 s49, s49, s74
    s_mov_b32 s74, s49
    s_cmp_ge_u32 s49, s75
    s_cselect_b32 s47, s50, 0
    s_add_u32 s49, s49, s47
    v_mov_b32 v21, s49
    s_waitcnt vmcnt(32)
    ds_write_b32 v20, v21
    s_mov_b32 m0, s46
    s_add_u32 s46, s46, 1024
    buffer_load_dwordx4 v11, s[64:67], s45 offen nt lds
    s_add_u32 s45, s45, 57344
    s_mov_b32 m0, s46
    s_add_u32 s46, s46, 1024
    buffer_load_dwordx4 v11, s[64:67], s45 offen nt lds
    s_add_u32 s45, s45, 57344
    s_mov_b32 m0, s46
    s_add_u32 s46, s46, 1024
    buffer_load_dwordx4 v11, s[64:67], s45 offen nt lds
    s_add_u32 s45, s45, 57344
    s_mov_b32 m0, s46
    s_add_u32 s46, s46, 1024
    buffer_load_dwordx4 v11, s[64:67], s45 offen nt lds
    s_add_u32 s45, s45, 57344
    s_add_u32 s48, s48, 4
    s_cmp_lt_u32 s46, 131072
    s_cbranch_scc1 L_ld_7
L_ldV:
    v_mov_b32 v23, 138948
    s_mov_b32 s34, 0
L_w_8:
    ds_read_b32 v22, v23
    s_add_u32 s34, s34, 1
    s_waitcnt lgkmcnt(0)
    v_readfirstlane_b32 s35, v22
    s_cmp_ge_u32 s35, 4
    s_cbranch_scc1 L_wd_9
    s_cmp_lt_u32 s34, 1000000
    s_cbranch_scc1 L_w_8
L_wd_9:
    s_mov_b32 s64, s8
    s_and_b32 s65, s9, 0xffff
    s_mov_b32 s66, 67108864
    s_mov_b32 s45, s42
    s_mov_b32 s46, 0
L_ld_10:
    s_sub_u32 s49, s48, 36
    s_max_i32 s49, s49, s74
    s_mov_b32 s74, s49
    s_cmp_ge_u32 s49, s75
    s_cselect_b32 s47, s50, 0
    s_add_u32 s49, s49, s47
    v_mov_b32 v21, s49
    s_waitcnt vmcnt(36)
    ds_write_b32 v20, v21
    s_mov_b32 m0, s46
    s_add_u32 s46, s46, 1024
    buffer_load_dwordx4 v16, s[64:67], s45 offen nt lds
    s_add_u32 s45, s45, 1024
    s_mov_b32 m0, s46
    s_add_u32 s46, s46, 1024
    buffer_load_dwordx4 v17, s[64:67], s45 offen nt lds
    s_add_u32 s45, s45, 1024
    s_mov_b32 m0, s46
    s_add_u32 s46, s46, 1024
    buffer_load_dwordx4 v16, s[64:67], s45 offen nt lds
    s_add_u32 s45, s45, 1024
    s_mov_b32 m0, s46
    s_add_u32 s46, s46, 1024
    buffer_load_dwordx4 v17, s[64:67], s45 offen nt lds
    s_add_u32 s45, s45, 1024
    s_add_u32 s48, s48, 4
    s_cmp_lt_u32 s46, 32768
    s_cbranch_scc1 L_ld_10
    s_cmp_eq_u32 s56, 1
    s_cbranch_scc1 L_ldW2
    v_mov_b32 v21, 124
    s_waitcnt vmcnt(36)
    ds_write_b32 v20, v21
    v_mov_b32 v21, 128
    s_waitcnt vmcnt(32)
    ds_write_b32 v20, v21
    v_mov_b32 v21, 132
    s_waitcnt vmcnt(28)
    ds_write_b32 v20, v21
    v_mov_b32 v21, 136
    s_waitcnt vmcnt(24)
    ds_write_b32 v20, v21
    v_mov_b32 v21, 140
    s_waitcnt vmcnt(20)
    ds_write_b32 v20, v21
    v_mov_b32 v21, 144
    s_waitcnt vmcnt(16)
    ds_write_b32 v20, v21
    v_mov_b32 v21, 148
    s_waitcnt vmcnt(12)
    ds_write_b32 v20, v21
    v_mov_b32 v21, 152
    s_waitcnt vmcnt(8)
    ds_write_b32 v20, v21
    v_mov_b32 v21, 156
    s_waitcnt vmcnt(4)
    ds_write_b32 v20, v21
    v_mov_b32 v21, 160
    s_waitcnt vmcnt(0)
    ds_write_b32 v20, v21
    s_endpgm
L_ldW2:
    s_mul_i32 s45, s57, 458752
    s_lshl_b32 s38, s58, 8
    s_add_u32 s45, s45, s38
    s_mov_b32 s64, s18
    s_and_b32 s65, s19, 0xffff
    s_mov_b32 s66, 0x700000
    s_mov_b32 s46, 65536
    v_mov_b32 v21, 128
    s_waitcnt vmcnt(32)
    ds_write_b32 v20, v21
    v_mov_b32 v21, 132
    s_waitcnt vmcnt(28)
    ds_write_b32 v20, v21
    v_mov_b32 v21, 136
    s_waitcnt vmcnt(24)
    ds_write_b32 v20, v21
    v_mov_b32 v21, 140
    s_waitcnt vmcnt(20)
    ds_write_b32 v20, v21
    v_mov_b32 v21, 144
    s_waitcnt vmcnt(16)
    ds_write_b32 v20, v21
    v_mov_b32 v21, 148
    s_waitcnt vmcnt(12)
    ds_write_b32 v20, v21
    v_mov_b32 v23, 138952
    s_mov_b32 s34, 0
L_w_11:
    ds_read_b32 v22, v23
    s_add_u32 s34, s34, 1
    s_waitcnt lgkmcnt(0)
    v_readfirstlane_b32 s35, v22
    s_cmp_ge_u32 s35, 4
    s_cbranch_scc1 L_wd_12
    s_cmp_lt_u32 s34, 1000000
    s_cbranch_scc1 L_w_11
L_wd_12:
    s_mov_b32 m0, s46
    s_add_u32 s46, s46, 1024
    buffer_load_dwordx4 v18, s[64:67], s45 offen nt lds
    s_add_u32 s45, s45, 8192
    s_mov_b32 m0, s46
    s_add_u32 s46, s46, 1024
    buffer_load_dwordx4 v19, s[64:67], s45 offen nt lds
    s_add_u32 s45, s45, 8192
    s_mov_b32 m0, s46
    s_add_u32 s46, s46, 1024
    buffer_load_dwordx4 v18, s[64:67], s45 offen nt lds
    s_add_u32 s45, s45, 8192
    s_mov_b32 m0, s46
    s_add_u32 s46, s46, 1024
    buffer_load_dwordx4 v19, s[64:67], s45 offen nt lds
    s_add_u32 s45, s45, 8192
    s_add_u32 s48, s48, 4
    s_mov_b32 m0, s46
    s_add_u32 s46, s46, 1024
    buffer_load_dwordx4 v18, s[64:67], s45 offen nt lds
    s_add_u32 s45, s45, 8192
    s_mov_b32 m0, s46
    s_add_u32 s46, s46, 1024
    buffer_load_dwordx4 v19, s[64:67], s45 offen nt lds
    s_add_u32 s45, s45, 8192
    s_mov_b32 m0, s46
    s_add_u32 s46, s46, 1024
    buffer_load_dwordx4 v18, s[64:67], s45 offen nt lds
    s_add_u32 s45, s45, 8192
    s_mov_b32 m0, s46
    s_add_u32 s46, s46, 1024
    buffer_load_dwordx4 v19, s[64:67], s45 offen nt lds
    s_add_u32 s45, s45, 8192
    s_add_u32 s48, s48, 4
    v_mov_b32 v21, 152
    s_waitcnt vmcnt(16)
    ds_write_b32 v20, v21
    v_mov_b32 v21, 156
    s_waitcnt vmcnt(12)
    ds_write_b32 v20, v21
    v_mov_b32 v21, 160
    s_waitcnt vmcnt(8)
    ds_write_b32 v20, v21
    v_mov_b32 v23, 138968
    s_mov_b32 s34, 0
L_w_13:
    ds_read_b32 v22, v23
    s_add_u32 s34, s34, 1
    s_waitcnt lgkmcnt(0)
    v_readfirstlane_b32 s35, v22
    s_cmp_ge_u32 s35, 4
    s_cbranch_scc1 L_wd_14
    s_cmp_lt_u32 s34, 1000000
    s_cbranch_scc1 L_w_13
L_wd_14:
    s_mov_b32 s48, 168
    s_mov_b32 s74, 160
    s_mov_b32 s50, 0
L_ld_15:
    s_sub_u32 s49, s48, 44
    s_max_i32 s49, s49, s74
    s_mov_b32 s74, s49
    s_cmp_ge_u32 s49, s75
    s_cselect_b32 s47, s50, 0
    s_add_u32 s49, s49, s47
    v_mov_b32 v21, s49
    s_waitcnt vmcnt(44)
    ds_write_b32 v20, v21
    s_mov_b32 m0, s46
    s_add_u32 s46, s46, 1024
    buffer_load_dwordx4 v18, s[64:67], s45 offen nt lds
    s_add_u32 s45, s45, 8192
    s_mov_b32 m0, s46
    s_add_u32 s46, s46, 1024
    buffer_load_dwordx4 v19, s[64:67], s45 offen nt lds
    s_add_u32 s45, s45, 8192
    s_mov_b32 m0, s46
    s_add_u32 s46, s46, 1024
    buffer_load_dwordx4 v18, s[64:67], s45 offen nt lds
    s_add_u32 s45, s45, 8192
    s_mov_b32 m0, s46
    s_add_u32 s46, s46, 1024
    buffer_load_dwordx4 v19, s[64:67], s45 offen nt lds
    s_add_u32 s45, s45, 8192
    s_add_u32 s48, s48, 4
    s_cmp_lt_u32 s46, 122880
    s_cbranch_scc1 L_ld_15
    v_mov_b32 v21, 172
    s_waitcnt vmcnt(44)
    ds_write_b32 v20, v21
    v_mov_b32 v21, 176
    s_waitcnt vmcnt(40)
    ds_write_b32 v20, v21
    v_mov_b32 v21, 180
    s_waitcnt vmcnt(36)
    ds_write_b32 v20, v21
    v_mov_b32 v21, 184
    s_waitcnt vmcnt(32)
    ds_write_b32 v20, v21
    v_mov_b32 v21, 188
    s_waitcnt vmcnt(28)
    ds_write_b32 v20, v21
    v_mov_b32 v21, 192
    s_waitcnt vmcnt(24)
    ds_write_b32 v20, v21
    v_mov_b32 v21, 196
    s_waitcnt vmcnt(20)
    ds_write_b32 v20, v21
    v_mov_b32 v21, 200
    s_waitcnt vmcnt(16)
    ds_write_b32 v20, v21
    v_mov_b32 v21, 204
    s_waitcnt vmcnt(12)
    ds_write_b32 v20, v21
    v_mov_b32 v21, 208
    s_waitcnt vmcnt(8)
    ds_write_b32 v20, v21
    v_mov_b32 v21, 212
    s_waitcnt vmcnt(4)
    ds_write_b32 v20, v21
    v_mov_b32 v21, 216
    s_waitcnt vmcnt(0)
    ds_write_b32 v20, v21
    s_endpgm
L_B:
    s_sub_u32 s33, s28, 1
    s_mov_b32 s59, 1
    s_cmp_ge_u32 s33, 2
    s_cbranch_scc1 L_B23
    v_lshrrev_b32 v5, 3, v1
    v_lshlrev_b32 v5, 6, v5
    v_and_b32 v6, 3, v1
    v_lshl_add_u32 v5, v6, 4, v5
    v_bfe_u32 v6, v1, 2, 1
    v_lshl_add_u32 v5, v6, 3, v5
    s_mul_i32 s30, s33, 576
    s_add_u32 s30, s30, 131072
    v_add_u32 v98, s30, v5
    v_mov_b32 v26, 0x3a800000
    s_barrier
    s_waitcnt vmcnt(1)
    v_readlane_b32 s30, v8, 0
    v_lshlrev_b32 v32, 16, v8
    v_and_b32 v33, 0xffff0000, v8
    v_lshlrev_b32 v34, 16, v9
    v_and_b32 v35, 0xffff0000, v9
    v_lshlrev_b32 v36, 16, v10
    v_and_b32 v37, 0xffff0000, v10
    v_lshlrev_b32 v38, 16, v11
    v_and_b32 v39, 0xffff0000, v11
    v_lshlrev_b32 v40, 16, v12
    v_and_b32 v41, 0xffff0000, v12
    v_lshlrev_b32 v42, 16, v13
    v_and_b32 v43, 0xffff0000, v13
    v_lshlrev_b32 v44, 16, v14
    v_and_b32 v45, 0xffff0000, v14
    v_lshlrev_b32 v46, 16, v15
    v_and_b32 v47, 0xffff0000, v15
    s_lshl_b32 s30, s30, 16
    s_mov_b32 s31, s30
    v_pk_add_f32 v[32:33], v[32:33], s[30:31] neg_lo:[0,1] neg_hi:[0,1]
    v_pk_add_f32 v[34:35], v[34:35], s[30:31] neg_lo:[0,1] neg_hi:[0,1]
    v_pk_add_f32 v[36:37], v[36:37], s[30:31] neg_lo:[0,1] neg_hi:[0,1]
    v_pk_add_f32 v[38:39], v[38:39], s[30:31] neg_lo:[0,1] neg_hi:[0,1]
    v_pk_add_f32 v[40:41], v[40:41], s[30:31] neg_lo:[0,1] neg_hi:[0,1]
    v_pk_add_f32 v[42:43], v[42:43], s[30:31] neg_lo:[0,1] neg_hi:[0,1]
    v_pk_add_f32 v[44:45], v[44:45], s[30:31] neg_lo:[0,1] neg_hi:[0,1]
    v_pk_add_f32 v[46:47], v[46:47], s[30:31] neg_lo:[0,1] neg_hi:[0,1]
    v_pk_add_f32 v[20:21], v[32:33], v[34:35]
    v_pk_mul_f32 v[22:23], v[32:33], v[32:33]
    v_pk_fma_f32 v[22:23], v[34:35], v[34:35], v[22:23]
    v_pk_add_f32 v[20:21], v[20:21], v[36:37]
    v_pk_fma_f32 v[22:23], v[36:37], v[36:37], v[22:23]
    v_pk_add_f32 v[20:21], v[20:21], v[38:39]
    v_pk_fma_f32 v[22:23], v[38:39], v[38:39], v[22:23]
    v_pk_add_f32 v[20:21], v[20:21], v[40:41]
    v_pk_fma_f32 v[22:23], v[40:41], v[40:41], v[22:23]
    v_pk_add_f32 v[20:21], v[20:21], v[42:43]
    v_pk_fma_f32 v[22:23], v[42:43], v[42:43], v[22:23]
    v_pk_add_f32 v[20:21], v[20:21], v[44:45]
    v_pk_fma_f32 v[22:23], v[44:45], v[44:45], v[22:23]
    v_pk_add_f32 v[20:21], v[20:21], v[46:47]
    v_pk_fma_f32 v[22:23], v[46:47], v[46:47], v[22:23]
    v_add_f32 v20, v20, v21
    v_add_f32 v22, v22, v23
    s_nop 0
    v_add_f32_dpp v20, v20, v20 quad_perm:[1,0,3,2] row_mask:0xf bank_mask:0xf
    v_add_f32_dpp v22, v22, v22 quad_perm:[1,0,3,2] row_mask:0xf bank_mask:0xf
    s_nop 0
    v_add_f32_dpp v20, v20, v20 quad_perm:[2,3,0,1] row_mask:0xf bank_mask:0xf
    v_add_f32_dpp v22, v22, v22 quad_perm:[2,3,0,1] row_mask:0xf bank_mask:0xf
    s_nop 0
    v_add_f32_dpp v20, v20, v20 row_half_mirror row_mask:0xf bank_mask:0xf
    v_add_f32_dpp v22, v22, v22 row_half_mirror row_mask:0xf bank_mask:0xf
    s_nop 0
    v_add_f32_dpp v20, v20, v20 row_mirror row_mask:0xf bank_mask:0xf
    v_add_f32_dpp v22, v22, v22 row_mirror row_mask:0xf bank_mask:0xf
    s_nop 0
    v_add_f32_dpp v20, v20, v20 row_bcast:15 row_mask:0xa bank_mask:0xf
    v_add_f32_dpp v22, v22, v22 row_bcast:15 row_mask:0xa bank_mask:0xf
    s_nop 0
    v_add_f32_dpp v20, v20, v20 row_bcast:31 row_mask:0xc bank_mask:0xf
    v_add_f32_dpp v22, v22, v22 row_bcast:31 row_mask:0xc bank_mask:0xf
    s_waitcnt vmcnt(0)
    v_readlane_b32 s40, v20, 63
    v_readlane_b32 s41, v22, 63
    v_lshlrev_b32 v32, 16, v16
    v_and_b32 v33, 0xffff0000, v16
    v_mul_f32 v20, s40, v26
    v_mul_f32 v22, s41, v26
    v_lshlrev_b32 v34, 16, v17
    v_and_b32 v35, 0xffff0000, v17
    v_fma_f32 v22, -v20, v20, v22
    v_add_f32 v20, s30, v20
    v_max_f32 v22, 0, v22
    v_cvt_pk_bf16_f32 v24, v20, v22
    v_lshlrev_b32 v20, 16, v24
    v_and_b32 v22, 0xffff0000, v24
    v_add_f32 v22, 0x3727c5ac, v22
    v_pk_add_f32 v[32:33], v[32:33], v[20:21] op_sel_hi:[1,0] neg_lo:[0,1] neg_hi:[0,1]
    v_cvt_pk_bf16_f32 v24, v22, v22
    v_pk_add_f32 v[34:35], v[34:35], v[20:21] op_sel_hi:[1,0] neg_lo:[0,1] neg_hi:[0,1]
    v_lshlrev_b32 v22, 16, v24
    v_cvt_pk_bf16_f32 v16, v32, v33
    v_sqrt_f32 v22, v22
    v_cvt_pk_bf16_f32 v17, v34, v35
    v_cvt_pk_bf16_f32 v24, v22, v22
    v_lshlrev_b32 v32, 16, v16
    v_lshlrev_b32 v22, 16, v24
    v_and_b32 v33, 0xffff0000, v16
    v_rcp_f32 v22, v22
    v_lshlrev_b32 v34, 16, v17
    v_and_b32 v35, 0xffff0000, v17
    v_pk_mul_f32 v[32:33], v[32:33], v[22:23] op_sel_hi:[1,0]
    v_pk_mul_f32 v[34:35], v[34:35], v[22:23] op_sel_hi:[1,0]
    v_cvt_pk_bf16_f32 v16, v32, v33
    v_cvt_pk_bf16_f32 v17, v34, v35
    ds_write_b64 v98, v[16:17]
    v_mov_b32 v127, 138944
    v_mov_b32 v126, 1
    s_mov_b64 exec, 1
    ds_add_u32 v127, v126
    s_mov_b64 exec, -1
    s_branch L_BC
L_B23:
    s_cmp_eq_u32 s33, 3
    s_cbranch_scc1 L_B3
    v_lshlrev_b32 v3, 4, v1
    v_add_u32 v3, 138112, v3
    v_mov_b32 v4, 0
    v_mov_b32 v5, 0
    v_mov_b32 v6, 0
    v_mov_b32 v7, 0
    v_cmp_gt_u32 vcc, 56, v1
    s_and_saveexec_b64 s[30:31], vcc
    ds_write_b128 v3, v[4:7]
    s_mov_b64 exec, -1
    s_waitcnt lgkmcnt(0)
L_B3:
    s_barrier
L_BC:
    s_add_u32 s32, s33, 4
    s_cmp_eq_u32 s56, 1
    s_cbranch_scc1 L_BY
    v_mov_b32 v127, 138688
    s_mov_b32 s34, 0
L_w_16:
    ds_read_b32 v126, v127
    s_add_u32 s34, s34, 1
    s_waitcnt lgkmcnt(0)
    v_readfirstlane_b32 s35, v126
    s_cmp_ge_u32 s35, 1
    s_cbranch_scc1 L_wd_17
    s_cmp_lt_u32 s34, 1000000
    s_cbranch_scc1 L_w_16
L_wd_17:
    s_and_b32 s29, s35, 255
    s_mov_b32 s51, s35
    v_mov_b32 v99, s29
    s_mov_b32 s39, 4294967040
    s_branch L_GS
L_BY:
    v_lshrrev_b32 v4, 2, v1
    v_lshlrev_b32 v4, 7, v4
    v_and_b32 v5, 3, v1
    v_lshl_add_u32 v4, v5, 3, v4
    v_bfe_u32 v5, v1, 3, 2
    v_xor_b32 v5, s33, v5
    v_lshl_add_u32 v100, v5, 5, v4
    v_add_u32 v100, 65536, v100
    s_sub_u32 s38, s37, 1
    s_cmp_gt_u32 s37, 3
    s_subb_u32 s38, s38, 0
    s_add_u32 s31, s26, 3
    s_and_b32 s31, s31, 7
    s_cmp_eq_u32 s31, 7
    s_cselect_b32 s31, 2, s31
    s_cmp_eq_u32 s38, s31
    s_cselect_b32 s30, 2, s38
    s_cmp_eq_u32 s38, 2
    s_cselect_b32 s38, s31, s30
    s_mul_i32 s31, s26, 7
    s_add_u32 s38, s38, s31
    v_lshrrev_b32 v4, 4, v1
    v_lshlrev_b32 v4, 4, v4
    v_and_b32 v5, 1, v1
    s_lshl_b32 s30, s38, 9
    s_mul_i32 s31, s36, 28672
    s_add_u32 s30, s30, s31
    s_lshl_b32 s31, s33, 7
    s_add_u32 s30, s30, s31
    s_add_u32 s30, s30, 196608
    v_lshlrev_b32 v6, 2, v1
    v_add_u32 v102, s30, v6
    s_mov_b32 s52, 64
    s_mov_b32 s60, 0
    s_branch L_PROJ
L_A:
    s_sub_u32 s33, s28, 5
    s_mov_b32 s32, s33
    s_setprio 2
    s_mov_b32 s59, 0
    s_barrier
    v_lshrrev_b32 v4, 2, v1
    v_lshlrev_b32 v4, 7, v4
    v_and_b32 v5, 3, v1
    v_lshl_add_u32 v4, v5, 3, v4
    v_bfe_u32 v5, v1, 3, 2
    v_xor_b32 v5, s33, v5
    v_lshl_add_u32 v100, v5, 5, v4
    s_lshl_b32 s38, s26, 3
    s_add_u32 s38, s38, s37
    v_lshrrev_b32 v4, 4, v1
    v_lshlrev_b32 v4, 4, v4
    v_and_b32 v5, 1, v1
    s_lshl_b32 s30, s38, 9
    s_mul_i32 s31, s36, 32768
    s_add_u32 s30, s30, s31
    s_lshl_b32 s31, s33, 7
    s_add_u32 s30, s30, s31
    s_add_u32 s30, s30, 65536
    v_lshlrev_b32 v6, 2, v1
    v_add_u32 v102, s30, v6
    s_mov_b32 s52, 0
L_PROJ:
    v_bfe_u32 v5, v1, 2, 1
    v_mul_u32_u24 v6, 576, v5
    s_mov_b32 s55, 131072
    v_add3_u32 v101, v6, v4, s55
    v_mov_b32 v127, 138944
    s_mov_b32 s34, 0
L_w_18:
    ds_read_b32 v126, v127
    s_add_u32 s34, s34, 1
    s_waitcnt lgkmcnt(0)
    v_readfirstlane_b32 s35, v126
    s_cmp_ge_u32 s35, 2
    s_cbranch_scc1 L_wd_19
    s_sleep 1
    s_cmp_lt_u32 s34, 1000000
    s_cbranch_scc1 L_w_18
L_wd_19:
    ds_read_b128 v[32:35], v101 offset:0
    ds_read_b128 v[36:39], v101 offset:64
    ds_read_b128 v[40:43], v101 offset:128
    ds_read_b128 v[44:47], v101 offset:192
    ds_read_b128 v[48:51], v101 offset:256
    ds_read_b128 v[52:55], v101 offset:320
    ds_read_b128 v[56:59], v101 offset:384
    ds_read_b128 v[60:63], v101 offset:448
    v_mov_b32 v127, 138688
    s_mov_b32 s34, 0
L_w_20:
    ds_read_b32 v126, v127
    s_add_u32 s34, s34, 1
    s_waitcnt lgkmcnt(0)
    v_readfirstlane_b32 s35, v126
    s_cmp_ge_u32 s35, 1
    s_cbranch_scc1 L_wd_21
    s_cmp_lt_u32 s34, 1000000
    s_cbranch_scc1 L_w_20
L_wd_21:
    s_and_b32 s29, s35, 255
    s_mov_b32 s51, s35
    v_mov_b32 v99, s29
    s_mov_b32 s39, 4294967040
    s_mov_b32 s46, 0x00030003
    s_mov_b32 s47, 0x00030003
L_PROJ2:
    s_add_u32 s54, s52, 16
    s_max_i32 s54, s54, 0
    v_mov_b32 v127, 138432
    s_mov_b32 s34, 0
L_w_22:
    ds_read_b32 v126, v127
    s_add_u32 s34, s34, 1
    s_waitcnt lgkmcnt(0)
    v_readfirstlane_b32 s35, v126
    s_cmp_ge_u32 s35, s54
    s_cbranch_scc1 L_wd_23
    s_sleep 1
    s_cmp_lt_u32 s34, 1000000
    s_cbranch_scc1 L_w_22
L_wd_23:
    ds_read_b64_tr_b16 v[64:65], v100 offset:0
    ds_read_b64_tr_b16 v[66:67], v100 offset:2048
    ds_read_b64_tr_b16 v[68:69], v100 offset:4096
    ds_read_b64_tr_b16 v[70:71], v100 offset:6144
    ds_read_b64_tr_b16 v[72:73], v100 offset:8192
    ds_read_b64_tr_b16 v[74:75], v100 offset:10240
    ds_read_b64_tr_b16 v[76:77], v100 offset:12288
    ds_read_b64_tr_b16 v[78:79], v100 offset:14336
    s_waitcnt lgkmcnt(6)
    v_mfma_f32_16x16x32_bf16 v[28:31], v[32:35], v[64:67], 0
    s_waitcnt lgkmcnt(4)
    v_mfma_f32_16x16x32_bf16 v[28:31], v[36:39], v[68:71], v[28:31]
    s_waitcnt lgkmcnt(2)
    v_mfma_f32_16x16x32_bf16 v[28:31], v[40:43], v[72:75], v[28:31]
    s_waitcnt lgkmcnt(0)
    v_mfma_f32_16x16x32_bf16 v[28:31], v[44:47], v[76:79], v[28:31]
    s_add_u32 s54, s52, 32
    s_max_i32 s54, s54, 0
    v_mov_b32 v127, 138432
    s_mov_b32 s34, 0
L_w_24:
    ds_read_b32 v126, v127
    s_add_u32 s34, s34, 1
    s_waitcnt lgkmcnt(0)
    v_readfirstlane_b32 s35, v126
    s_cmp_ge_u32 s35, s54
    s_cbranch_scc1 L_wd_25
    s_sleep 1
    s_cmp_lt_u32 s34, 1000000
    s_cbranch_scc1 L_w_24
L_wd_25:
    ds_read_b64_tr_b16 v[64:65], v100 offset:16384
    ds_read_b64_tr_b16 v[66:67], v100 offset:18432
    ds_read_b64_tr_b16 v[68:69], v100 offset:20480
    ds_read_b64_tr_b16 v[70:71], v100 offset:22528
    ds_read_b64_tr_b16 v[72:73], v100 offset:24576
    ds_read_b64_tr_b16 v[74:75], v100 offset:26624
    ds_read_b64_tr_b16 v[76:77], v100 offset:28672
    ds_read_b64_tr_b16 v[78:79], v100 offset:30720
    s_waitcnt lgkmcnt(6)
    v_mfma_f32_16x16x32_bf16 v[28:31], v[48:51], v[64:67], v[28:31]
    s_waitcnt lgkmcnt(4)
    v_mfma_f32_16x16x32_bf16 v[28:31], v[52:55], v[68:71], v[28:31]
    s_waitcnt lgkmcnt(2)
    v_mfma_f32_16x16x32_bf16 v[28:31], v[56:59], v[72:75], v[28:31]
    s_waitcnt lgkmcnt(0)
    v_mfma_f32_16x16x32_bf16 v[28:31], v[60:63], v[76:79], v[28:31]
    s_nop 7
    v_and_or_b32 v28, v28, s39, v99
    s_mov_b64 exec, 0xffffffff
    global_store_dword v102, v28, s[24:25] sc1
    s_mov_b64 exec, -1
    s_cmp_eq_u32 s59, 0
    s_cbranch_scc1 L_PA
    s_cmp_eq_u32 s60, 1
    s_cbranch_scc1 L_PB
    s_cmp_eq_u32 s37, 3
    s_cbranch_scc1 L_PB
    s_mov_b32 s60, 1
    v_add_u32 v100, 32768, v100
    s_sub_u32 s38, s37, 1
    s_cmp_gt_u32 s37, 3
    s_subb_u32 s38, s38, 0
    s_add_u32 s38, s38, 1
    s_add_u32 s31, s26, 3
    s_and_b32 s31, s31, 7
    s_cmp_eq_u32 s31, 7
    s_cselect_b32 s31, 2, s31
    s_cmp_eq_u32 s38, s31
    s_cselect_b32 s30, 2, s38
    s_cmp_eq_u32 s38, 2
    s_cselect_b32 s38, s31, s30
    s_mul_i32 s31, s26, 7
    s_add_u32 s38, s38, s31
    v_lshrrev_b32 v4, 4, v1
    v_lshlrev_b32 v4, 4, v4
    v_and_b32 v5, 1, v1
    s_lshl_b32 s30, s38, 9
    s_mul_i32 s31, s36, 28672
    s_add_u32 s30, s30, s31
    s_lshl_b32 s31, s33, 7
    s_add_u32 s30, s30, s31
    s_add_u32 s30, s30, 196608
    v_lshlrev_b32 v6, 2, v1
    v_add_u32 v102, s30, v6
    s_mov_b32 s52, 96
    s_branch L_PROJ2
L_PB:
    v_mov_b32 v127, 138952
    v_mov_b32 v126, 1
    s_mov_b64 exec, 1
    ds_add_u32 v127, v126
    s_mov_b64 exec, -1
    s_branch L_GS
L_PA:
    v_mov_b32 v127, 138948
    v_mov_b32 v126, 1
    s_mov_b64 exec, 1
    ds_add_u32 v127, v126
    s_mov_b64 exec, -1
L_GS:
    v_lshrrev_b32 v4, 4, v1
    v_lshlrev_b32 v4, 4, v4
    v_and_b32 v5, 1, v1
    v_mul_u32_u24 v5, 576, v5
    s_mov_b32 s55, 134400
    v_add3_u32 v104, v5, v4, s55
    v_lshrrev_b32 v5, 2, v1
    v_and_b32 v6, 3, v1
    v_lshlrev_b32 v6, 3, v6
    v_lshl_add_u32 v6, v5, 8, v6
    v_and_b32 v5, 7, v5
    v_xor_b32 v7, s32, v5
    v_lshl_add_u32 v106, v7, 5, v6
    v_add_u32 v106, 65536, v106
    s_lshl_b32 s30, s33, 1
    v_xor_b32 v7, s30, v5
    v_lshl_add_u32 v110, v7, 5, v6
    v_xor_b32 v7, 1, v7
    v_lshl_add_u32 v111, v7, 5, v6
    v_lshlrev_b32 v5, 3, v1
    s_lshl_b32 s30, s26, 1
    s_add_u32 s30, s30, s56
    s_lshl_b32 s30, s30, 4
    s_add_u32 s30, s30, s57
    s_lshl_b32 s30, s30, 10
    s_lshl_b32 s31, s32, 7
    s_add_u32 s30, s30, s31
    s_add_u32 s30, s30, 393216
    v_add_u32 v108, s30, v5
    s_cmp_eq_u32 s59, 0
    s_cbranch_scc1 L_ATT
    v_mov_b32 v127, 138980
    s_mov_b32 s34, 0
L_w_26:
    ds_read_b32 v126, v127
    s_add_u32 s34, s34, 1
    s_waitcnt lgkmcnt(0)
    v_readfirstlane_b32 s35, v126
    s_cmp_ge_u32 s35, 1
    s_cbranch_scc1 L_wd_27
    s_sleep 4
    s_cmp_lt_u32 s34, 1000000
    s_cbranch_scc1 L_w_26
L_wd_27:
    s_mov_b32 s53, s35
    s_cmp_eq_u32 s56, 0
    s_cbranch_scc1 L_GX
    s_cmp_ge_u32 s33, 2
    s_cbranch_scc1 L_GY
    v_min_u32 v5, 55, v1
    v_lshrrev_b32 v6, 2, v5
    v_lshlrev_b32 v3, 7, v6
    v_and_b32 v6, 3, v5
    v_lshl_add_u32 v3, v6, 4, v3
    s_mul_i32 s30, s57, 1792
    s_lshl_b32 s31, s33, 6
    s_add_u32 s30, s30, s31
    s_add_u32 s30, s30, 196608
    v_add_u32 v8, s30, v3
    v_add_u32 v9, 28672, v8
    v_add_u32 v10, 57344, v8
    v_add_u32 v11, 86016, v8
    v_mov_b32 v127, 138432
    s_mov_b32 s34, 0
L_w_28:
    ds_read_b32 v126, v127
    s_add_u32 s34, s34, 1
    s_waitcnt lgkmcnt(0)
    v_readfirstlane_b32 s35, v126
    s_cmp_ge_u32 s35, 152
    s_cbranch_scc1 L_wd_29
    s_sleep 2
    s_cmp_lt_u32 s34, 1000000
    s_cbranch_scc1 L_w_28
L_wd_29:
    v_mov_b32 v127, 138968
    s_mov_b32 s34, 0
L_w_30:
    ds_read_b32 v126, v127
    s_add_u32 s34, s34, 1
    s_waitcnt lgkmcnt(0)
    v_readfirstlane_b32 s35, v126
    s_cmp_ge_u32 s35, 4
    s_cbranch_scc1 L_wd_31
    s_cmp_lt_u32 s34, 1000000
    s_cbranch_scc1 L_w_30
L_wd_31:
    s_mov_b32 s34, 0
L_HP:
    global_load_dwordx4 v[32:35], v8, s[24:25] sc1
    global_load_dwordx4 v[36:39], v9, s[24:25] sc1
    global_load_dwordx4 v[40:43], v10, s[24:25] sc1
    global_load_dwordx4 v[44:47], v11, s[24:25] sc1
    s_add_u32 s34, s34, 1
    s_waitcnt vmcnt(0)
    v_xor_b32 v32, v32, v99
    v_xor_b32 v33, v33, v99
    v_xor_b32 v34, v34, v99
    v_xor_b32 v35, v35, v99
    v_xor_b32 v36, v36, v99
    v_xor_b32 v37, v37, v99
    v_xor_b32 v38, v38, v99
    v_xor_b32 v39, v39, v99
    v_xor_b32 v40, v40, v99
    v_xor_b32 v41, v41, v99
    v_xor_b32 v42, v42, v99
    v_xor_b32 v43, v43, v99
    v_xor_b32 v44, v44, v99
    v_xor_b32 v45, v45, v99
    v_xor_b32 v46, v46, v99
    v_xor_b32 v47, v47, v99
    v_or3_b32 v27, v32, v33, v34
    v_or3_b32 v27, v35, v36, v27
    v_or3_b32 v27, v37, v38, v27
    v_or3_b32 v27, v39, v40, v27
    v_or3_b32 v27, v41, v42, v27
    v_or3_b32 v27, v43, v44, v27
    v_or3_b32 v27, v45, v46, v27
    v_or_b32 v27, v47, v27
    v_and_b32 v27, 255, v27
    v_cmp_ne_u32 vcc, 0, v27
    s_cmp_gt_u32 s34, 1000000
    s_cbranch_scc1 L_HD
    s_cbranch_vccnz L_HP
L_HD:
    v_pk_add_f32 v[32:33], v[32:33], v[36:37]
    v_pk_add_f32 v[34:35], v[34:35], v[38:39]
    v_pk_add_f32 v[40:41], v[40:41], v[44:45]
    v_pk_add_f32 v[42:43], v[42:43], v[46:47]
    v_pk_add_f32 v[32:33], v[32:33], v[40:41]
    v_pk_add_f32 v[34:35], v[34:35], v[42:43]
    v_max_f32 v32, 0, v32
    v_max_f32 v33, 0, v33
    v_max_f32 v34, 0, v34
    v_max_f32 v35, 0, v35
    v_cvt_pk_bf16_f32 v36, v32, v33
    v_cvt_pk_bf16_f32 v37, v34, v35
    ds_write_b64 v98, v[36:37] offset:3328
    v_mov_b32 v127, 138972
    v_mov_b32 v126, 1
    s_mov_b64 exec, 1
    ds_add_u32 v127, v126
    s_mov_b64 exec, -1
    s_branch L_GY
L_ATT:
    s_lshr_b32 s30, s26, 2
    s_lshl_b32 s30, s30, 6
    s_and_b32 s31, s26, 3
    s_lshl_b32 s31, s31, 13
    s_add_u32 s30, s30, s31
    s_lshl_b32 s31, s33, 11
    s_add_u32 s30, s30, s31
    s_add_u32 s30, s30, 65536
    v_lshrrev_b32 v4, 2, v1
    v_lshlrev_b32 v4, 7, v4
    v_and_b32 v5, 3, v1
    v_lshl_add_u32 v4, v5, 4, v4
    v_add_u32 v8, s30, v4
    v_add_u32 v9, 32768, v8
    v_add_u32 v10, 65536, v8
    v_add_u32 v11, 98304, v8
    v_lshrrev_b32 v4, 5, v1
    v_mul_u32_u24 v4, 272, v4
    v_and_b32 v5, 31, v1
    v_lshl_add_u32 v4, v5, 3, v4
    s_mul_i32 s30, s33, 544
    s_add_u32 s30, s30, 132224
    v_add_u32 v12, s30, v4
    v_lshrrev_b32 v4, 4, v1
    v_lshlrev_b32 v5, 4, v4
    v_and_b32 v3, 7, v1
    v_mul_u32_u24 v6, 272, v3
    v_add_u32 v6, v6, v5
    v_add_u32 v6, 132224, v6
    v_add_u32 v5, 138112, v5
    v_bfe_u32 v7, v1, 3, 1
    v_cmp_eq_u32 vcc, 0, v7
    v_lshlrev_b32 v19, 7, v4
    v_lshl_add_u32 v19, v3, 4, v19
    v_cndmask_b32 v13, v5, v6, vcc
    v_cndmask_b32 v14, v6, v5, vcc
    v_add_u32 v19, 136064, v19
    s_lshl_b32 s30, s33, 9
    v_lshl_add_u32 v114, v7, 3, v19
    v_add_u32 v114, s30, v114
    v_cndmask_b32 v116, v5, v19, vcc
    v_cndmask_b32 v117, v19, v5, vcc
    v_mov_b32 v6, 0x200
    v_cndmask_b32 v118, 0, v6, vcc
    v_cndmask_b32 v119, v6, 0, vcc
    v_lshlrev_b32 v113, 4, v3
    v_add_u32 v113, 135808, v113
    s_lshl_b32 s30, s33, 2
    v_add_u32 v112, s30, v113
    v_and_b32 v5, 15, v1
    s_lshl_b32 s30, s33, 13
    s_add_u32 s30, s30, 32768
    v_add_u32 v6, 0, v4
    v_xor_b32 v6, v6, v5
    v_lshlrev_b32 v6, 4, v6
    v_lshl_add_u32 v6, v5, 8, v6
    v_add_u32 v15, s30, v6
    v_add_u32 v6, 4, v4
    v_xor_b32 v6, v6, v5
    v_lshlrev_b32 v6, 4, v6
    v_lshl_add_u32 v6, v5, 8, v6
    v_add_u32 v16, s30, v6
    v_add_u32 v6, 8, v4
    v_xor_b32 v6, v6, v5
    v_lshlrev_b32 v6, 4, v6
    v_lshl_add_u32 v6, v5, 8, v6
    v_add_u32 v17, s30, v6
    v_add_u32 v6, 12, v4
    v_xor_b32 v6, v6, v5
    v_lshlrev_b32 v6, 4, v6
    v_lshl_add_u32 v6, v5, 8, v6
    v_add_u32 v18, s30, v6
    v_lshlrev_b32 v96, 14, v3
    v_lshl_add_u32 v96, v7, 6, v96
    v_lshl_add_u32 v96, v4, 4, v96
    s_lshl_b32 s30, s26, 17
    s_lshl_b32 s31, s27, 7
    s_add_u32 s30, s30, s31
    s_lshl_b32 s31, s33, 12
    s_add_u32 s30, s30, s31
    s_add_u32 s30, s30, 655360
    v_add_u32 v96, s30, v96
    v_lshrrev_b32 v97, 3, v1
    v_lshlrev_b32 v97, 14, v97
    v_lshl_add_u32 v97, v3, 4, v97
    v_add_u32 v97, s30, v97
    v_lshlrev_b32 v115, 4, v1
    s_lshl_b32 s30, s26, 12
    s_lshl_b32 s31, s27, 7
    s_add_u32 s30, s30, s31
    s_add_u32 s30, s30, 327680
    v_add_u32 v115, s30, v115
    s_mov_b32 s40, 0x3db504f3
    s_mov_b32 s41, 0x3fb8aa3b
    v_xor_b32 v20, 0x55, v99
    v_mov_b32 v21, v20
    v_mov_b32 v22, v20
    v_mov_b32 v23, v20
    global_store_dwordx4 v97, v[20:23], s[24:25] sc1
    s_mov_b32 s54, 72
    s_mov_b32 s55, 64
    s_cmp_eq_u32 s37, 3
    s_cselect_b32 s54, 56, s54
    v_mov_b32 v127, 138432
    s_mov_b32 s34, 0
L_w_32:
    ds_read_b32 v126, v127
    s_add_u32 s34, s34, 1
    s_waitcnt lgkmcnt(0)
    v_readfirstlane_b32 s35, v126
    s_cmp_ge_u32 s35, s54
    s_cbranch_scc1 L_wd_33
    s_sleep 2
    s_cmp_lt_u32 s34, 1000000
    s_cbranch_scc1 L_w_32
L_wd_33:
    s_mov_b32 s34, 0
L_QP:
    global_load_dwordx4 v[64:67], v8, s[24:25] sc1
    global_load_dwordx4 v[68:71], v9, s[24:25] sc1
    global_load_dwordx4 v[72:75], v10, s[24:25] sc1
    global_load_dwordx4 v[76:79], v11, s[24:25] sc1
    s_add_u32 s34, s34, 1
    s_waitcnt vmcnt(0)
    v_xor_b32 v64, v64, v99
    v_xor_b32 v65, v65, v99
    v_xor_b32 v66, v66, v99
    v_xor_b32 v67, v67, v99
    v_xor_b32 v68, v68, v99
    v_xor_b32 v69, v69, v99
    v_xor_b32 v70, v70, v99
    v_xor_b32 v71, v71, v99
    v_xor_b32 v72, v72, v99
    v_xor_b32 v73, v73, v99
    v_xor_b32 v74, v74, v99
    v_xor_b32 v75, v75, v99
    v_xor_b32 v76, v76, v99
    v_xor_b32 v77, v77, v99
    v_xor_b32 v78, v78, v99
    v_xor_b32 v79, v79, v99
    v_or3_b32 v27, v64, v65, v66
    v_or3_b32 v27, v67, v68, v27
    v_or3_b32 v27, v69, v70, v27
    v_or3_b32 v27, v71, v72, v27
    v_or3_b32 v27, v73, v74, v27
    v_or3_b32 v27, v75, v76, v27
    v_or3_b32 v27, v77, v78, v27
    v_or_b32 v27, v79, v27
    v_and_b32 v27, 255, v27
    v_cmp_ne_u32 vcc, 0, v27
    s_cmp_gt_u32 s34, 1000000
    s_cbranch_scc1 L_QD
    s_cbranch_vccnz L_QP
L_QD:
    v_pk_add_f32 v[64:65], v[64:65], v[68:69]
    v_pk_add_f32 v[66:67], v[66:67], v[70:71]
    v_pk_add_f32 v[72:73], v[72:73], v[76:77]
    v_pk_add_f32 v[74:75], v[74:75], v[78:79]
    v_pk_add_f32 v[64:65], v[64:65], v[72:73]
    v_pk_add_f32 v[66:67], v[66:67], v[74:75]
    v_cvt_pk_bf16_f32 v64, v64, v65
    v_cvt_pk_bf16_f32 v65, v66, v67
    ds_write_b64 v12, v[64:65]
    v_mov_b32 v127, 138956
    v_mov_b32 v126, 1
    s_mov_b64 exec, 1
    ds_add_u32 v127, v126
    s_mov_b64 exec, -1
    v_mov_b32 v127, 138432
    s_mov_b32 s34, 0
L_w_34:
    ds_read_b32 v126, v127
    s_add_u32 s34, s34, 1
    s_waitcnt lgkmcnt(0)
    v_readfirstlane_b32 s35, v126
    s_cmp_ge_u32 s35, s55
    s_cbranch_scc1 L_wd_35
    s_sleep 1
    s_cmp_lt_u32 s34, 1000000
    s_cbranch_scc1 L_w_34
L_wd_35:
    ds_read_b128 v[32:35], v15 offset:0
    ds_read_b128 v[48:51], v15 offset:4096
    ds_read_b128 v[36:39], v16 offset:0
    ds_read_b128 v[52:55], v16 offset:4096
    ds_read_b128 v[40:43], v17 offset:0
    ds_read_b128 v[56:59], v17 offset:4096
    ds_read_b128 v[44:47], v18 offset:0
    ds_read_b128 v[60:63], v18 offset:4096
    v_mov_b32 v127, 138980
    s_mov_b32 s34, 0
L_w_36:
    ds_read_b32 v126, v127
    s_add_u32 s34, s34, 1
    s_waitcnt lgkmcnt(0)
    v_readfirstlane_b32 s35, v126
    s_cmp_ge_u32 s35, 1
    s_cbranch_scc1 L_wd_37
    s_cmp_lt_u32 s34, 1000000
    s_cbranch_scc1 L_w_36
L_wd_37:
    s_mov_b32 s53, s35
    v_mov_b32 v127, 138956
    s_mov_b32 s34, 0
L_w_38:
    ds_read_b32 v126, v127
    s_add_u32 s34, s34, 1
    s_waitcnt lgkmcnt(0)
    v_readfirstlane_b32 s35, v126
    s_cmp_ge_u32 s35, 4
    s_cbranch_scc1 L_wd_39
    s_cmp_lt_u32 s34, 1000000
    s_cbranch_scc1 L_w_38
L_wd_39:
    ds_read_b128 v[64:67], v13 offset:0
    ds_read_b128 v[80:83], v14 offset:0
    ds_read_b128 v[68:71], v13 offset:64
    ds_read_b128 v[84:87], v14 offset:64
    ds_read_b128 v[72:75], v13 offset:128
    ds_read_b128 v[88:91], v14 offset:128
    ds_read_b128 v[76:79], v13 offset:192
    ds_read_b128 v[92:95], v14 offset:192
    s_waitcnt lgkmcnt(7)
    v_mfma_f32_16x16x32_bf16 v[28:31], v[32:35], v[64:67], 0
    s_waitcnt lgkmcnt(6)
    v_mfma_f32_16x16x32_bf16 v[28:31], v[48:51], v[80:83], v[28:31]
    s_waitcnt lgkmcnt(5)
    v_mfma_f32_16x16x32_bf16 v[28:31], v[36:39], v[68:71], v[28:31]
    s_waitcnt lgkmcnt(4)
    v_mfma_f32_16x16x32_bf16 v[28:31], v[52:55], v[84:87], v[28:31]
    s_waitcnt lgkmcnt(3)
    v_mfma_f32_16x16x32_bf16 v[28:31], v[40:43], v[72:75], v[28:31]
    s_waitcnt lgkmcnt(2)
    v_mfma_f32_16x16x32_bf16 v[28:31], v[56:59], v[88:91], v[28:31]
    s_waitcnt lgkmcnt(1)
    v_mfma_f32_16x16x32_bf16 v[28:31], v[44:47], v[76:79], v[28:31]
    s_waitcnt lgkmcnt(0)
    v_mfma_f32_16x16x32_bf16 v[28:31], v[60:63], v[92:95], v[28:31]
    s_nop 7
    v_cvt_pk_bf16_f32 v64, v28, v29
    v_cvt_pk_bf16_f32 v65, v30, v31
    v_lshlrev_b32 v28, 16, v64
    v_and_b32 v29, 0xffff0000, v64
    v_lshlrev_b32 v30, 16, v65
    v_and_b32 v31, 0xffff0000, v65
    v_pk_mul_f32 v[28:29], v[28:29], s[40:41] op_sel_hi:[1,0]
    v_pk_mul_f32 v[30:31], v[30:31], s[40:41] op_sel_hi:[1,0]
    v_cvt_pk_bf16_f32 v64, v28, v29
    v_cvt_pk_bf16_f32 v65, v30, v31
    v_lshlrev_b32 v28, 16, v64
    v_and_b32 v29, 0xffff0000, v64
    v_lshlrev_b32 v30, 16, v65
    v_and_b32 v31, 0xffff0000, v65
    v_max3_f32 v66, v28, v29, v30
    v_max_f32 v66, v66, v31
    s_nop 1
    v_max_f32_dpp v66, v66, v66 row_ror:8 row_mask:0xf bank_mask:0xf
    v_mov_b32 v67, v66
    s_nop 1
    v_permlane16_swap_b32 v66, v67
    v_max_f32 v66, v66, v67
    v_mov_b32 v67, v66
    s_nop 1
    v_permlane32_swap_b32 v66, v67
    v_max_f32 v66, v66, v67
    ds_write_b32 v112, v66
    v_mov_b32 v127, 138960
    v_mov_b32 v126, 1
    s_mov_b64 exec, 1
    ds_add_u32 v127, v126
    s_mov_b64 exec, -1
    v_mov_b32 v127, 138960
    s_mov_b32 s34, 0
L_w_40:
    ds_read_b32 v126, v127
    s_add_u32 s34, s34, 1
    s_waitcnt lgkmcnt(0)
    v_readfirstlane_b32 s35, v126
    s_cmp_ge_u32 s35, 4
    s_cbranch_scc1 L_wd_41
    s_cmp_lt_u32 s34, 1000000
    s_cbranch_scc1 L_w_40
L_wd_41:
    ds_read_b128 v[68:71], v113
    s_waitcnt lgkmcnt(0)
    v_max3_f32 v66, v68, v69, v70
    v_max_f32 v66, v66, v71
    v_sub_f32 v28, v28, v66
    v_sub_f32 v29, v29, v66
    v_sub_f32 v30, v30, v66
    v_sub_f32 v31, v31, v66
    v_mul_f32 v28, s41, v28
    v_mul_f32 v29, s41, v29
    v_mul_f32 v30, s41, v30
    v_mul_f32 v31, s41, v31
    v_exp_f32 v28, v28
    v_exp_f32 v29, v29
    v_exp_f32 v30, v30
    v_exp_f32 v31, v31
    v_mov_b32 v20, v66
    v_cvt_pk_bf16_f32 v64, v28, v29
    v_cvt_pk_bf16_f32 v65, v30, v31
    v_add_f32 v67, v28, v29
    v_add_f32 v68, v30, v31
    ds_write_b64 v114, v[64:65]
    v_add_f32 v67, v67, v68
    s_nop 1
    v_add_f32_dpp v67, v67, v67 row_ror:8 row_mask:0xf bank_mask:0xf
    v_mov_b32 v68, v67
    s_nop 1
    v_permlane16_swap_b32 v67, v68
    v_add_f32 v67, v67, v68
    v_mov_b32 v68, v67
    s_nop 1
    v_permlane32_swap_b32 v67, v68
    v_add_f32 v67, v67, v68
    ds_write_b32 v112, v67 offset:128
    v_mov_b32 v127, 138964
    v_mov_b32 v126, 1
    s_mov_b64 exec, 1
    ds_add_u32 v127, v126
    s_mov_b64 exec, -1
    v_mov_b32 v127, 138964
    s_mov_b32 s34, 0
L_w_42:
    ds_read_b32 v126, v127
    s_add_u32 s34, s34, 1
    s_waitcnt lgkmcnt(0)
    v_readfirstlane_b32 s35, v126
    s_cmp_ge_u32 s35, 4
    s_cbranch_scc1 L_wd_43
    s_cmp_lt_u32 s34, 1000000
    s_cbranch_scc1 L_w_42
L_wd_43:
    s_cmp_lg_u32 s33, 0
    s_cbranch_scc1 L_noml
    ds_read_b128 v[24:27], v113 offset:128
    v_or_b32 v20, v20, v99
    s_waitcnt lgkmcnt(0)
    v_add_f32 v24, v24, v25
    v_add_f32 v26, v26, v27
    v_add_f32 v22, v24, v26
    v_mov_b32 v21, s51
    v_mov_b32 v23, s51
    v_and_or_b32 v22, v22, s39, v99
    s_mov_b64 exec, 0xff
    s_cmp_eq_u32 s53, 1
    s_cbranch_scc1 L_st_44
    global_store_dwordx4 v115, v[20:23], s[24:25] sc1
    s_branch L_se_45
L_st_44:
    global_store_dwordx4 v115, v[20:23], s[24:25]
L_se_45:
    s_mov_b64 exec, -1
L_noml:
    global_load_dwordx4 v[122:125], v97, s[24:25] sc1
    ds_read_b128 v[64:67], v116
    ds_read_b128 v[68:71], v117
    v_add_u32 v116, v116, v118
    v_add_u32 v117, v117, v119
    ds_read_b128 v[72:75], v116
    ds_read_b128 v[76:79], v117
    v_add_u32 v116, v116, v118
    v_add_u32 v117, v117, v119
    ds_read_b128 v[80:83], v116
    ds_read_b128 v[84:87], v117
    v_add_u32 v116, v116, v118
    v_add_u32 v117, v117, v119
    ds_read_b128 v[88:91], v116
    ds_read_b128 v[92:95], v117
    v_mov_b32 v127, 138432
    s_mov_b32 s34, 0
L_w_46:
    ds_read_b32 v126, v127
    s_add_u32 s34, s34, 1
    s_waitcnt lgkmcnt(0)
    v_readfirstlane_b32 s35, v126
    s_cmp_ge_u32 s35, 144
    s_cbranch_scc1 L_wd_47
    s_sleep 2
    s_cmp_lt_u32 s34, 1000000
    s_cbranch_scc1 L_w_46
L_wd_47:
    ds_read_b64_tr_b16 v[32:33], v110 offset:0
    ds_read_b64_tr_b16 v[34:35], v110 offset:4096
    ds_read_b64_tr_b16 v[36:37], v111 offset:0
    ds_read_b64_tr_b16 v[38:39], v111 offset:4096
    ds_read_b64_tr_b16 v[40:41], v110 offset:8192
    ds_read_b64_tr_b16 v[42:43], v110 offset:12288
    ds_read_b64_tr_b16 v[44:45], v111 offset:8192
    ds_read_b64_tr_b16 v[46:47], v111 offset:12288
    s_waitcnt lgkmcnt(6)
    v_mfma_f32_16x16x32_bf16 v[28:31], v[32:35], v[64:67], 0
    s_waitcnt lgkmcnt(4)
    v_mfma_f32_16x16x32_bf16 v[28:31], v[36:39], v[68:71], v[28:31]
    s_waitcnt lgkmcnt(2)
    v_mfma_f32_16x16x32_bf16 v[28:31], v[40:43], v[72:75], v[28:31]
    s_waitcnt lgkmcnt(0)
    v_mfma_f32_16x16x32_bf16 v[28:31], v[44:47], v[76:79], v[28:31]
    v_mov_b32 v127, 138432
    s_mov_b32 s34, 0
L_w_48:
    ds_read_b32 v126, v127
    s_add_u32 s34, s34, 1
    s_waitcnt lgkmcnt(0)
    v_readfirstlane_b32 s35, v126
    s_cmp_ge_u32 s35, 152
    s_cbranch_scc1 L_wd_49
    s_sleep 2
    s_cmp_lt_u32 s34, 1000000
    s_cbranch_scc1 L_w_48
L_wd_49:
    ds_read_b64_tr_b16 v[32:33], v110 offset:16384
    ds_read_b64_tr_b16 v[34:35], v110 offset:20480
    ds_read_b64_tr_b16 v[36:37], v111 offset:16384
    ds_read_b64_tr_b16 v[38:39], v111 offset:20480
    s_waitcnt lgkmcnt(2)
    v_mfma_f32_16x16x32_bf16 v[28:31], v[32:35], v[80:83], v[28:31]
    s_waitcnt lgkmcnt(0)
    v_mfma_f32_16x16x32_bf16 v[28:31], v[36:39], v[84:87], v[28:31]
    v_mov_b32 v127, 138432
    s_mov_b32 s34, 0
L_w_50:
    ds_read_b32 v126, v127
    s_add_u32 s34, s34, 1
    s_waitcnt lgkmcnt(0)
    v_readfirstlane_b32 s35, v126
    s_cmp_ge_u32 s35, 160
    s_cbranch_scc1 L_wd_51
    s_cmp_lt_u32 s34, 1000000
    s_cbranch_scc1 L_w_50
L_wd_51:
    ds_read_b64_tr_b16 v[32:33], v110 offset:24576
    ds_read_b64_tr_b16 v[34:35], v110 offset:28672
    ds_read_b64_tr_b16 v[36:37], v111 offset:24576
    ds_read_b64_tr_b16 v[38:39], v111 offset:28672
    s_waitcnt lgkmcnt(2)
    v_mfma_f32_16x16x32_bf16 v[28:31], v[32:35], v[88:91], v[28:31]
    s_waitcnt lgkmcnt(0)
    v_mfma_f32_16x16x32_bf16 v[28:31], v[36:39], v[92:95], v[28:31]
    s_nop 1
    s_nop 5
    v_and_or_b32 v28, v28, s39, v99
    v_and_or_b32 v29, v29, s39, v99
    v_and_or_b32 v30, v30, s39, v99
    v_and_or_b32 v31, v31, s39, v99
    s_cmp_eq_u32 s53, 1
    s_cbranch_scc1 L_st_52
    global_store_dwordx4 v96, v[28:31], s[24:25] sc1
    s_branch L_se_53
L_st_52:
    global_store_dwordx4 v96, v[28:31], s[24:25]
L_se_53:
    v_mov_b32 v127, 138968
    v_mov_b32 v126, 1
    s_mov_b64 exec, 1
    ds_add_u32 v127, v126
    s_mov_b64 exec, -1
    s_cmp_eq_u32 s56, 1
    s_cbranch_scc1 L_GY
L_GX:
    v_mov_b32 v127, 138432
    s_mov_b32 s34, 0
L_w_54:
    ds_read_b32 v126, v127
    s_add_u32 s34, s34, 1
    s_waitcnt lgkmcnt(0)
    v_readfirstlane_b32 s35, v126
    s_cmp_ge_u32 s35, 128
    s_cbranch_scc1 L_wd_55
    s_sleep 2
    s_cmp_lt_u32 s34, 1000000
    s_cbranch_scc1 L_w_54
L_wd_55:
    ds_read_b64_tr_b16 v[64:65], v106 offset:0
    ds_read_b64_tr_b16 v[66:67], v106 offset:4096
    ds_read_b64_tr_b16 v[68:69], v106 offset:8192
    ds_read_b64_tr_b16 v[70:71], v106 offset:12288
    ds_read_b64_tr_b16 v[72:73], v106 offset:16384
    ds_read_b64_tr_b16 v[74:75], v106 offset:20480
    ds_read_b64_tr_b16 v[76:77], v106 offset:24576
    ds_read_b64_tr_b16 v[78:79], v106 offset:28672
    s_waitcnt lgkmcnt(0)
    ds_read_b64_tr_b16 v[80:81], v106 offset:32768
    ds_read_b64_tr_b16 v[82:83], v106 offset:36864
    ds_read_b64_tr_b16 v[84:85], v106 offset:40960
    ds_read_b64_tr_b16 v[86:87], v106 offset:45056
    ds_read_b64_tr_b16 v[88:89], v106 offset:49152
    ds_read_b64_tr_b16 v[90:91], v106 offset:53248
    ds_read_b64_tr_b16 v[92:93], v106 offset:57344
    ds_read_b64_tr_b16 v[94:95], v106 offset:61440
    v_mov_b32 v127, 138968
    s_mov_b32 s34, 0
L_w_56:
    ds_read_b32 v126, v127
    s_add_u32 s34, s34, 1
    s_waitcnt lgkmcnt(0)
    v_readfirstlane_b32 s35, v126
    s_cmp_ge_u32 s35, 4
    s_cbranch_scc1 L_wd_57
    s_sleep 2
    s_cmp_lt_u32 s34, 1000000
    s_cbranch_scc1 L_w_56
L_wd_57:
    v_mov_b32 v127, 138972
    s_mov_b32 s34, 0
L_w_58:
    ds_read_b32 v126, v127
    s_add_u32 s34, s34, 1
    s_waitcnt lgkmcnt(0)
    v_readfirstlane_b32 s35, v126
    s_cmp_ge_u32 s35, 2
    s_cbranch_scc1 L_wd_59
    s_cmp_lt_u32 s34, 1000000
    s_cbranch_scc1 L_w_58
L_wd_59:
    ds_read_b128 v[32:35], v104 offset:0
    ds_read_b128 v[36:39], v104 offset:64
    ds_read_b128 v[40:43], v104 offset:128
    ds_read_b128 v[44:47], v104 offset:192
    ds_read_b128 v[48:51], v104 offset:256
    ds_read_b128 v[52:55], v104 offset:320
    ds_read_b128 v[56:59], v104 offset:384
    ds_read_b128 v[60:63], v104 offset:448
    s_waitcnt lgkmcnt(7)
    v_mfma_f32_16x16x32_bf16 v[28:31], v[32:35], v[64:67], 0
    s_waitcnt lgkmcnt(6)
    v_mfma_f32_16x16x32_bf16 v[28:31], v[36:39], v[68:71], v[28:31]
    s_waitcnt lgkmcnt(5)
    v_mfma_f32_16x16x32_bf16 v[28:31], v[40:43], v[72:75], v[28:31]
    s_waitcnt lgkmcnt(4)
    v_mfma_f32_16x16x32_bf16 v[28:31], v[44:47], v[76:79], v[28:31]
    s_waitcnt lgkmcnt(3)
    v_mfma_f32_16x16x32_bf16 v[28:31], v[48:51], v[80:83], v[28:31]
    s_waitcnt lgkmcnt(2)
    v_mfma_f32_16x16x32_bf16 v[28:31], v[52:55], v[84:87], v[28:31]
    s_waitcnt lgkmcnt(1)
    v_mfma_f32_16x16x32_bf16 v[28:31], v[56:59], v[88:91], v[28:31]
    s_waitcnt lgkmcnt(0)
    v_mfma_f32_16x16x32_bf16 v[28:31], v[60:63], v[92:95], v[28:31]
    s_branch L_GE
L_GY:
    v_mov_b32 v127, 138972
    s_mov_b32 s34, 0
L_w_60:
    ds_read_b32 v126, v127
    s_add_u32 s34, s34, 1
    s_waitcnt lgkmcnt(0)
    v_readfirstlane_b32 s35, v126
    s_cmp_ge_u32 s35, 2
    s_cbranch_scc1 L_wd_61
    s_sleep 1
    s_cmp_lt_u32 s34, 1000000
    s_cbranch_scc1 L_w_60
L_wd_61:
    ds_read_b128 v[32:35], v104 offset:0
    ds_read_b128 v[36:39], v104 offset:64
    ds_read_b128 v[40:43], v104 offset:128
    ds_read_b128 v[44:47], v104 offset:192
    ds_read_b128 v[48:51], v104 offset:256
    ds_read_b128 v[52:55], v104 offset:320
    ds_read_b128 v[56:59], v104 offset:384
    v_mov_b32 v127, 138432
    s_mov_b32 s34, 0
L_w_62:
    ds_read_b32 v126, v127
    s_add_u32 s34, s34, 1
    s_waitcnt lgkmcnt(0)
    v_readfirstlane_b32 s35, v126
    s_cmp_ge_u32 s35, 192
    s_cbranch_scc1 L_wd_63
    s_cmp_lt_u32 s34, 1000000
    s_cbranch_scc1 L_w_62
L_wd_63:
    ds_read_b64_tr_b16 v[64:65], v106 offset:0
    ds_read_b64_tr_b16 v[66:67], v106 offset:4096
    ds_read_b64_tr_b16 v[68:69], v106 offset:8192
    ds_read_b64_tr_b16 v[70:71], v106 offset:12288
    ds_read_b64_tr_b16 v[72:73], v106 offset:16384
    ds_read_b64_tr_b16 v[74:75], v106 offset:20480
    ds_read_b64_tr_b16 v[76:77], v106 offset:24576
    ds_read_b64_tr_b16 v[78:79], v106 offset:28672
    s_waitcnt lgkmcnt(6)
    v_mfma_f32_16x16x32_bf16 v[28:31], v[32:35], v[64:67], 0
    s_waitcnt lgkmcnt(4)
    v_mfma_f32_16x16x32_bf16 v[28:31], v[36:39], v[68:71], v[28:31]
    s_waitcnt lgkmcnt(2)
    v_mfma_f32_16x16x32_bf16 v[28:31], v[40:43], v[72:75], v[28:31]
    s_waitcnt lgkmcnt(0)
    v_mfma_f32_16x16x32_bf16 v[28:31], v[44:47], v[76:79], v[28:31]
    v_mov_b32 v127, 138432
    s_mov_b32 s34, 0
L_w_64:
    ds_read_b32 v126, v127
    s_add_u32 s34, s34, 1
    s_waitcnt lgkmcnt(0)
    v_readfirstlane_b32 s35, v126
    s_cmp_ge_u32 s35, 208
    s_cbranch_scc1 L_wd_65
    s_cmp_lt_u32 s34, 1000000
    s_cbranch_scc1 L_w_64
L_wd_65:
    ds_read_b64_tr_b16 v[80:81], v106 offset:32768
    ds_read_b64_tr_b16 v[82:83], v106 offset:36864
    ds_read_b64_tr_b16 v[84:85], v106 offset:40960
    ds_read_b64_tr_b16 v[86:87], v106 offset:45056
    s_waitcnt lgkmcnt(2)
    v_mfma_f32_16x16x32_bf16 v[28:31], v[48:51], v[80:83], v[28:31]
    s_waitcnt lgkmcnt(0)
    v_mfma_f32_16x16x32_bf16 v[28:31], v[52:55], v[84:87], v[28:31]
    v_mov_b32 v127, 138432
    s_mov_b32 s34, 0
L_w_66:
    ds_read_b32 v126, v127
    s_add_u32 s34, s34, 1
    s_waitcnt lgkmcnt(0)
    v_readfirstlane_b32 s35, v126
    s_cmp_ge_u32 s35, 216
    s_cbranch_scc1 L_wd_67
    s_cmp_lt_u32 s34, 1000000
    s_cbranch_scc1 L_w_66
L_wd_67:
    ds_read_b64_tr_b16 v[88:89], v106 offset:49152
    ds_read_b64_tr_b16 v[90:91], v106 offset:53248
    s_waitcnt lgkmcnt(0)
    v_mfma_f32_16x16x32_bf16 v[28:31], v[56:59], v[88:91], v[28:31]
L_GE:
    s_nop 7
    v_and_or_b32 v28, v28, s39, v99
    v_and_or_b32 v29, v29, s39, v99
    s_mov_b64 exec, 0xffff
    s_cmp_eq_u32 s53, 1
    s_cbranch_scc1 L_st_68
    global_store_dwordx2 v108, v[28:29], s[24:25] sc1
    s_branch L_se_69
L_st_68:
    global_store_dwordx2 v108, v[28:29], s[24:25]
L_se_69:
    s_mov_b64 exec, -1
    v_mov_b32 v127, 138976
    v_mov_b32 v126, 1
    s_mov_b64 exec, 1
    ds_add_u32 v127, v126
    s_mov_b64 exec, -1
    s_endpgm
L_C:
    s_setprio 2
    s_sub_u32 s33, s28, 9
    s_cmp_eq_u32 s33, 0
    s_cbranch_scc1 L_C0
    s_barrier
    s_cmp_eq_u32 s56, 1
    s_cbranch_scc1 L_end
    v_mov_b32 v50, 0
    v_mov_b32 v52, 0
    v_mov_b32 v127, 138688
    s_mov_b32 s34, 0
L_w_70:
    ds_read_b32 v126, v127
    s_add_u32 s34, s34, 1
    s_waitcnt lgkmcnt(0)
    v_readfirstlane_b32 s35, v126
    s_cmp_ge_u32 s35, 1
    s_cbranch_scc1 L_wd_71
    s_cmp_lt_u32 s34, 1000000
    s_cbranch_scc1 L_w_70
L_wd_71:
    s_and_b32 s29, s35, 255
    s_mov_b32 s51, s35
    v_mov_b32 v99, s29
    s_mov_b32 s39, 4294967040
    s_branch L_CC
L_C0:
    s_waitcnt lgkmcnt(0)
    s_load_dword s51, s[24:25], 0
    s_mov_b32 s62, 1703936
    s_load_dword s63, s[24:25], s62
    s_barrier
    v_lshlrev_b32 v3, 2, v1
    v_add_u32 v3, 138688, v3
    s_waitcnt lgkmcnt(0)
    s_add_u32 s30, s63, 1
    s_xor_b32 s31, s30, s51
    s_and_b32 s31, s31, 255
    s_cmp_eq_u32 s31, 0
    s_addc_u32 s30, s30, 0
    s_and_b32 s30, s30, 255
    s_mul_i32 s51, s51, 1664525
    s_mul_i32 s63, s63, 22695477
    s_add_u32 s51, s51, s63
    s_add_u32 s51, s51, 1013904223
    s_and_b32 s51, s51, 4294967040
    s_or_b32 s51, s51, s30
    s_or_b32 s51, s51, 0x1000
    v_mov_b32 v4, s51
    ds_write_b32 v3, v4
    s_and_b32 s29, s51, 255
    v_mov_b32 v99, s29
    s_getreg_b32 s44, hwreg(HW_REG_XCC_ID)
    s_and_b32 s44, s44, 0xff
    s_lshl_b32 s44, s44, 8
    s_or_b32 s44, s44, s29
    s_lshl_b32 s30, s26, 12
    s_lshl_b32 s31, s27, 7
    s_add_u32 s31, s30, s31
    s_add_u32 s31, s31, 32768
    v_lshlrev_b32 v4, 2, v1
    v_add_u32 v4, s31, v4
    v_mov_b32 v5, s44
    s_mov_b64 exec, 0xffffffff
    global_store_dword v4, v5, s[24:25] sc1
    s_mov_b64 exec, -1
    v_and_b32 v7, 31, v1
    v_lshlrev_b32 v9, 7, v7
    s_add_u32 s30, s30, 32768
    v_add_u32 v9, s30, v9
    v_bfe_u32 v4, v1, 4, 1
    v_lshlrev_b32 v4, 11, v4
    v_and_b32 v5, 1, v1
    v_lshl_add_u32 v4, v5, 2, v4
    v_bfe_u32 v6, v1, 1, 1
    v_lshl_add_u32 v4, v6, 1, v4
    v_cmp_eq_u32 s[60:61], 1, v6
    s_lshl_b32 s30, s58, 8
    s_lshl_b32 s31, s27, 3
    s_add_u32 s30, s30, s31
    v_add_u32 v50, s30, v4
    global_load_ushort v51, v50, s[4:5]
    s_lshl_b32 s30, s26, 15
    s_lshl_b32 s31, s27, 5
    s_add_u32 s30, s30, s31
    s_add_u32 s30, s30, 393216
    v_lshrrev_b32 v4, 1, v1
    v_lshlrev_b32 v4, 10, v4
    v_lshl_add_u32 v4, v5, 4, v4
    v_add_u32 v52, s30, v4
    v_mov_b32 v127, 138432
    s_mov_b32 s34, 0
L_w_72:
    ds_read_b32 v126, v127
    s_add_u32 s34, s34, 1
    s_waitcnt lgkmcnt(0)
    v_readfirstlane_b32 s35, v126
    s_cmp_ge_u32 s35, 48
    s_cbranch_scc1 L_wd_73
    s_sleep 4
    s_cmp_lt_u32 s34, 1000000
    s_cbranch_scc1 L_w_72
L_wd_73:
    s_mov_b32 s34, 0
    s_branch L_XCS
L_XCP:
    s_sleep 8
L_XCS:
    global_load_dwordx4 v[28:31], v9, s[24:25] sc1
    s_add_u32 s34, s34, 1
    s_waitcnt vmcnt(0)
    v_xor_b32 v28, v28, v99
    v_xor_b32 v29, v29, v99
    v_xor_b32 v30, v30, v99
    v_xor_b32 v31, v31, v99
    v_or3_b32 v27, v28, v29, v30
    v_or_b32 v27, v31, v27
    v_and_b32 v27, 255, v27
    v_cmp_ne_u32 vcc, 0, v27
    s_cmp_gt_u32 s34, 1000000
    s_cbranch_scc1 L_XCD
    s_cbranch_vccnz L_XCP
L_XCD:
    s_xor_b32 s44, s44, s29
    v_cmp_ne_u32 vcc, s44, v28
    s_mov_b32 s53, 1
    s_cmp_lg_u64 vcc, 0
    s_cselect_b32 s53, 2, s53
    v_mov_b32 v127, 138980
    v_mov_b32 v126, s53
    s_mov_b64 exec, 1
    ds_write_b32 v127, v126
    s_mov_b64 exec, -1
    v_lshlrev_b32 v51, 16, v51
    global_load_dwordx4 v[56:59], v52, s[24:25] sc1
    s_cmp_eq_u32 s56, 1
    s_cbranch_scc1 L_FIN
L_CC:
    s_lshl_b32 s38, s57, 1
    s_add_u32 s38, s38, s33
    s_mov_b32 s41, 0x3fb8aa3b
    s_mov_b32 s42, 0x07060302
    v_and_b32 v7, 31, v1
    v_lshrrev_b32 v4, 5, v1
    v_lshlrev_b32 v5, 14, v4
    v_lshl_add_u32 v5, v7, 4, v5
    s_lshl_b32 s30, s38, 9
    s_add_u32 s30, s30, 360448
    v_add_u32 v24, s30, v5
    v_lshrrev_b32 v5, 3, v7
    v_lshlrev_b32 v5, 6, v5
    v_and_b32 v6, 3, v7
    v_lshl_add_u32 v5, v6, 4, v5
    v_bfe_u32 v6, v7, 2, 1
    v_lshl_add_u32 v5, v6, 3, v5
    v_mul_u32_u24 v6, 576, v4
    s_lshl_b32 s30, s33, 8
    s_add_u32 s30, s30, 134400
    v_add3_u32 v25, v5, v6, s30
    v_lshlrev_b32 v10, 7, v7
    s_lshl_b32 s30, s26, 12
    s_lshr_b32 s31, s38, 2
    s_lshl_b32 s31, s31, 4
    s_add_u32 s30, s30, s31
    s_add_u32 s30, s30, 327680
    v_add_u32 v10, s30, v10
    s_lshl_b32 s30, s33, 7
    s_add_u32 s30, s30, 135552
    v_lshlrev_b32 v11, 2, v7
    v_add_u32 v11, s30, v11
    v_lshrrev_b32 v4, 3, v1
    v_lshlrev_b32 v12, 4, v4
    v_add_u32 v12, s30, v12
    v_lshlrev_b32 v8, 9, v4
    v_and_b32 v5, 7, v1
    v_lshl_add_u32 v8, v5, 4, v8
    s_lshl_b32 s30, s26, 17
    s_lshl_b32 s31, s38, 12
    s_add_u32 s30, s30, s31
    s_add_u32 s30, s30, 655360
    v_add_u32 v8, s30, v8
    v_lshlrev_b32 v13, 4, v5
    s_lshl_b32 s30, s26, 12
    s_lshl_b32 s31, s38, 7
    s_add_u32 s30, s30, s31
    s_add_u32 s30, s30, 360448
    v_add_u32 v13, s30, v13
    s_mov_b32 s46, 0x00ff00ff
    s_mov_b32 s47, 0x00ff00ff
    s_mov_b32 s43, 0xffff0000
    s_lshl_b32 s30, s26, 17
    s_lshl_b32 s31, s38, 12
    s_add_u32 s30, s30, s31
    s_lshl_b32 s31, s27, 7
    s_add_u32 s30, s30, s31
    s_add_u32 s30, s30, 655360
    s_load_dword s62, s[24:25], s30
    s_add_u32 s30, s30, 64
    s_load_dword s62, s[24:25], s30
    s_lshl_b32 s30, s26, 12
    s_lshl_b32 s31, s38, 7
    s_add_u32 s30, s30, s31
    s_add_u32 s30, s30, 327680
    s_load_dword s62, s[24:25], s30
    s_add_u32 s30, s30, 64
    s_load_dword s62, s[24:25], s30
    s_waitcnt lgkmcnt(0)
    v_mov_b32 v127, 138432
    s_mov_b32 s34, 0
L_w_74:
    ds_read_b32 v126, v127
    s_add_u32 s34, s34, 1
    s_waitcnt lgkmcnt(0)
    v_readfirstlane_b32 s35, v126
    s_cmp_ge_u32 s35, 152
    s_cbranch_scc1 L_wd_75
    s_sleep 4
    s_cmp_lt_u32 s34, 1000000
    s_cbranch_scc1 L_w_74
L_wd_75:
    s_mov_b32 s34, 0
L_MLP:
    global_load_dwordx4 v[28:31], v10, s[24:25] sc1
    s_add_u32 s34, s34, 1
    s_waitcnt vmcnt(0)
    v_xor_b32 v14, v28, v99
    v_xor_b32 v15, v30, v99
    v_or_b32 v27, v14, v15
    v_and_b32 v27, 255, v27
    v_xor_b32 v29, s51, v29
    v_xor_b32 v31, s51, v31
    v_or3_b32 v27, v27, v29, v31
    v_cmp_ne_u32 vcc, 0, v27
    s_cmp_gt_u32 s34, 1000000
    s_cbranch_scc1 L_MLD
    s_cbranch_vccnz L_MLP
L_MLD:
    v_mov_b32 v16, v14
    s_nop 1
    v_max_f32_dpp v16, v16, v16 quad_perm:[1,0,3,2] row_mask:0xf bank_mask:0xf
    s_nop 1
    v_max_f32_dpp v16, v16, v16 quad_perm:[2,3,0,1] row_mask:0xf bank_mask:0xf
    s_nop 1
    v_max_f32_dpp v16, v16, v16 row_half_mirror row_mask:0xf bank_mask:0xf
    s_nop 1
    v_max_f32_dpp v16, v16, v16 row_mirror row_mask:0xf bank_mask:0xf
    v_mov_b32 v17, v16
    s_nop 1
    v_permlane16_swap_b32 v16, v17
    v_max_f32 v16, v16, v17
    v_sub_f32 v14, v14, v16
    v_mul_f32 v14, s41, v14
    v_exp_f32 v14, v14
    s_nop 0
    v_mul_f32 v16, v14, v15
    s_nop 1
    v_add_f32_dpp v16, v16, v16 quad_perm:[1,0,3,2] row_mask:0xf bank_mask:0xf
    s_nop 1
    v_add_f32_dpp v16, v16, v16 quad_perm:[2,3,0,1] row_mask:0xf bank_mask:0xf
    s_nop 1
    v_add_f32_dpp v16, v16, v16 row_half_mirror row_mask:0xf bank_mask:0xf
    s_nop 1
    v_add_f32_dpp v16, v16, v16 row_mirror row_mask:0xf bank_mask:0xf
    v_mov_b32 v17, v16
    s_nop 1
    v_permlane16_swap_b32 v16, v17
    v_add_f32 v16, v16, v17
    v_rcp_f32 v16, v16
    s_nop 0
    v_mul_f32 v14, v14, v16
    ds_write_b32 v11, v14
    ds_read_b128 v[20:23], v12
    v_mov_b32 v127, 138968
    s_mov_b32 s34, 0
L_w_76:
    ds_read_b32 v126, v127
    s_add_u32 s34, s34, 1
    s_waitcnt lgkmcnt(0)
    v_readfirstlane_b32 s35, v126
    s_cmp_ge_u32 s35, 1
    s_cbranch_scc1 L_wd_77
    s_cmp_lt_u32 s34, 1000000
    s_cbranch_scc1 L_w_76
L_wd_77:
    s_mov_b32 s34, 0
L_O1P:
    global_load_dwordx4 v[32:35], v8, s[24:25] offset:0 sc1
    global_load_dwordx4 v[36:39], v8, s[24:25] offset:128 sc1
    global_load_dwordx4 v[40:43], v8, s[24:25] offset:256 sc1
    global_load_dwordx4 v[44:47], v8, s[24:25] offset:384 sc1
    s_add_u32 s34, s34, 1
    s_waitcnt vmcnt(0)
    v_xor_b32 v32, v32, v99
    v_xor_b32 v33, v33, v99
    v_xor_b32 v34, v34, v99
    v_xor_b32 v35, v35, v99
    v_xor_b32 v36, v36, v99
    v_xor_b32 v37, v37, v99
    v_xor_b32 v38, v38, v99
    v_xor_b32 v39, v39, v99
    v_xor_b32 v40, v40, v99
    v_xor_b32 v41, v41, v99
    v_xor_b32 v42, v42, v99
    v_xor_b32 v43, v43, v99
    v_xor_b32 v44, v44, v99
    v_xor_b32 v45, v45, v99
    v_xor_b32 v46, v46, v99
    v_xor_b32 v47, v47, v99
    v_or3_b32 v27, v32, v33, v34
    v_or3_b32 v27, v35, v36, v27
    v_or3_b32 v27, v37, v38, v27
    v_or3_b32 v27, v39, v40, v27
    v_or3_b32 v27, v41, v42, v27
    v_or3_b32 v27, v43, v44, v27
    v_or3_b32 v27, v45, v46, v27
    v_or_b32 v27, v47, v27
    v_and_b32 v27, 255, v27
    v_cmp_ne_u32 vcc, 0, v27
    s_cmp_gt_u32 s34, 1000000
    s_cbranch_scc1 L_O1D
    s_cbranch_vccnz L_O1P
L_O1D:
    v_pk_mul_f32 v[16:17], v[32:33], v[20:21] op_sel_hi:[1,0]
    v_pk_mul_f32 v[18:19], v[34:35], v[20:21] op_sel_hi:[1,0]
    v_pk_fma_f32 v[16:17], v[36:37], v[20:21], v[16:17] op_sel:[0,1,0] op_sel_hi:[1,1,1]
    v_pk_fma_f32 v[18:19], v[38:39], v[20:21], v[18:19] op_sel:[0,1,0] op_sel_hi:[1,1,1]
    v_pk_fma_f32 v[16:17], v[40:41], v[22:23], v[16:17] op_sel_hi:[1,0,1]
    v_pk_fma_f32 v[18:19], v[42:43], v[22:23], v[18:19] op_sel_hi:[1,0,1]
    v_pk_fma_f32 v[16:17], v[44:45], v[22:23], v[16:17] op_sel:[0,1,0] op_sel_hi:[1,1,1]
    v_pk_fma_f32 v[18:19], v[46:47], v[22:23], v[18:19] op_sel:[0,1,0] op_sel_hi:[1,1,1]
    s_nop 0
    v_permlane32_swap_b32 v16, v17
    v_permlane32_swap_b32 v18, v19
    v_add_f32 v16, v16, v17
    v_add_f32 v18, v18, v19
    s_nop 1
    v_permlane16_swap_b32 v16, v18
    v_add_f32 v16, v16, v18
    s_nop 1
    v_add_f32_dpp v16, v16, v16 row_ror:8 row_mask:0xf bank_mask:0xf
    v_cvt_pk_bf16_f32 v16, v16, v16
    v_and_or_b32 v16, v16, s43, v99
    v_mov_b32 v18, v16
    s_nop 1
    v_permlane16_swap_b32 v16, v18
    v_mov_b32 v17, v16
    v_mov_b32 v19, v18
    s_nop 0
    v_permlane32_swap_b32 v16, v17
    v_permlane32_swap_b32 v18, v19
    s_mov_b64 exec, 0xff
    global_store_dwordx4 v13, v[16:19], s[24:25] sc1
    s_mov_b64 exec, -1
    s_mov_b32 s34, 0
L_O2P:
    global_load_dwordx4 v[20:23], v24, s[24:25] sc1
    s_add_u32 s34, s34, 1
    s_waitcnt vmcnt(0)
    v_xor_b32 v20, v20, v99
    v_xor_b32 v21, v21, v99
    v_xor_b32 v22, v22, v99
    v_xor_b32 v23, v23, v99
    v_or3_b32 v27, v20, v21, v22
    v_or_b32 v27, v23, v27
    v_and_b32 v27, 255, v27
    v_cmp_ne_u32 vcc, 0, v27
    s_cmp_gt_u32 s34, 1000000
    s_cbranch_scc1 L_O2D
    s_cbranch_vccnz L_O2P
L_O2D:
    v_perm_b32 v28, v21, v20, s42
    v_perm_b32 v29, v23, v22, s42
    ds_write_b64 v25, v[28:29]
    v_mov_b32 v127, 138972
    v_mov_b32 v126, 1
    s_mov_b64 exec, 1
    ds_add_u32 v127, v126
    s_mov_b64 exec, -1
    s_cmp_eq_u32 s33, 1
    s_cbranch_scc1 L_CE
L_FIN:
    s_mov_b32 s46, 0x000f000f
    s_mov_b32 s47, 0
    v_mov_b32 v127, 138976
    s_mov_b32 s34, 0
L_w_78:
    ds_read_b32 v126, v127
    s_add_u32 s34, s34, 1
    s_waitcnt lgkmcnt(0)
    v_readfirstlane_b32 s35, v126
    s_cmp_ge_u32 s35, 1
    s_cbranch_scc1 L_wd_79
    s_sleep 1
    s_cmp_lt_u32 s34, 1000000
    s_cbranch_scc1 L_w_78
L_wd_79:
    s_mov_b32 s34, 0
L_FSP:
    global_load_dwordx4 v[8:11], v52, s[24:25] sc1
    s_add_u32 s34, s34, 1
    s_waitcnt vmcnt(0)
    v_xor_b32 v8, v8, v99
    v_xor_b32 v9, v9, v99
    v_xor_b32 v10, v10, v99
    v_xor_b32 v11, v11, v99
    v_or3_b32 v16, v8, v9, v10
    v_or_b32 v16, v11, v16
    v_and_b32 v16, 255, v16
    v_cmp_ne_u32 vcc, 0, v16
    s_cmp_gt_u32 s34, 1000000
    s_cbranch_scc1 L_FSD
    s_cbranch_vccnz L_FSP
L_FSD:
    v_permlane16_swap_b32 v8, v9
    v_permlane16_swap_b32 v10, v11
    v_add_f32 v8, v8, v9
    v_add_f32 v10, v10, v11
    s_nop 0
    v_add_f32_dpp v8, v8, v8 row_ror:2 row_mask:0xf bank_mask:0xf
    v_add_f32_dpp v10, v10, v10 row_ror:2 row_mask:0xf bank_mask:0xf
    s_nop 0
    v_add_f32_dpp v8, v8, v8 row_ror:4 row_mask:0xf bank_mask:0xf
    v_add_f32_dpp v10, v10, v10 row_ror:4 row_mask:0xf bank_mask:0xf
    s_nop 0
    v_add_f32_dpp v8, v8, v8 row_ror:8 row_mask:0xf bank_mask:0xf
    v_add_f32_dpp v10, v10, v10 row_ror:8 row_mask:0xf bank_mask:0xf
    v_cndmask_b32 v8, v8, v10, s[60:61]
    v_mov_b32 v12, v8
    s_nop 1
    v_permlane32_swap_b32 v8, v12
    v_cvt_pk_bf16_f32 v9, v8, v12
    v_and_b32 v12, 0xffff0000, v9
    v_mul_f32 v10, 0xbfb8aa3b, v12
    v_exp_f32 v10, v10
    v_lshlrev_b32 v8, 16, v9
    v_add_f32 v10, 1.0, v10
    v_rcp_f32 v10, v10
    s_nop 0
    v_mul_f32 v10, v12, v10
    v_cvt_pk_bf16_f32 v10, v10, v10
    v_lshlrev_b32 v10, 16, v10
    v_mul_f32 v10, v8, v10
    v_cvt_pk_bf16_f32 v10, v10, v10
    v_lshlrev_b32 v10, 16, v10
    v_add_f32 v10, v51, v10
    v_cvt_pk_bf16_f32 v10, v10, v10
    s_mov_b64 exec, s[46:47]
    global_store_short v50, v10, s[20:21]
    s_cmp_lg_u32 s2, 0
    s_cbranch_scc1 L_PEND
    s_mov_b64 exec, 1
    v_mov_b32 v4, 0
    v_mov_b32 v5, s51
    global_store_dword v4, v5, s[24:25] offset:0
    v_mov_b32 v6, 1703936
    global_store_dword v6, v5, s[24:25]
L_PEND:
L_CE:
L_end:
    s_endpgm

.section .rodata,"a"
.p2align 6
.amdhsa_kernel recurrent_scan__sliding_block_cached__dense_activation_relu__decode_kernel
  .amdhsa_next_free_vgpr 128
  .amdhsa_next_free_sgpr 102
  .amdhsa_accum_offset 128
  .amdhsa_group_segment_fixed_size 0
  .amdhsa_kernarg_size 88
  .amdhsa_user_sgpr_count 2
  .amdhsa_user_sgpr_kernarg_segment_ptr 1
  .amdhsa_system_sgpr_workgroup_id_x 1
.end_amdhsa_kernel
```
